```python
import torch

def _softmax(x, axis=-1):
    return torch.softmax(x, dim=axis)
def _gelu(x):
    return torch.nn.functional.gelu(x, approximate="tanh")
def _silu(x):
    return torch.nn.functional.silu(x)
def _sigmoid(x):
    return torch.sigmoid(x)
def _layernorm(x, axis=-1, eps=1e-5):
    m = x.mean(dim=axis, keepdim=True)
    v = x.var(dim=axis, keepdim=True, unbiased=False)
    return (x - m) / torch.sqrt(v + eps)
def _scatter_add(tgt, idx, src, axis=0):
    return tgt.clone().index_add_(axis, idx, src)
def _segment_sum(src, seg, n):
    out = torch.zeros((n,) + src.shape[1:], dtype=src.dtype)
    return out.index_add_(0, seg, src)
def _pad(x, pw):
    flat = tuple(v for pair in reversed(pw) for v in pair)
    return torch.nn.functional.pad(x, flat)

kernel_name = 'concat_heads__linear_attn_block__spectral_gfnet__prompt'

def setup_inputs():

    _w = (lambda a: (lambda t: t.to(torch.bfloat16) if t.is_floating_point() else t)(torch.as_tensor(a)))
    def _A_setup():
        B, S, D = 1, 2048, 1024
        return {
            "x": _w((lambda *s: torch.randn(*s, dtype=torch.bfloat16) * 0.05)(B, S, D)),
            "wqkv": _w((lambda *s: torch.randn(*s, dtype=torch.bfloat16) * 0.4)(D, 3 * D)),
            "wo": _w((lambda *s: torch.randn(*s, dtype=torch.bfloat16) * 0.05)(D, D)),
        }
    _A_in = _A_setup()

    def _B_setup():
        B, S, D = 1, 2048, 1024
        Df = D // 2 + 1
        return {
            "x": _w((lambda *s: torch.randn(*s, dtype=torch.bfloat16) * 0.05)(B, S, D)),
            "w_r": _w((lambda *s: torch.randn(*s, dtype=torch.bfloat16) * 1.6)(S, Df) * 0.02),
            "w_i": _w((lambda *s: torch.randn(*s, dtype=torch.bfloat16) * 1.6)(S, Df) * 0.02),
        }
    _B_in = _B_setup()

    return {
        "A_x": _A_in["x"],
        "A_wqkv": _A_in["wqkv"],
        "A_wo": _A_in["wo"],
        "B_x": _B_in["x"],
        "B_w_r": _B_in["w_r"],
        "B_w_i": _B_in["w_i"],
    }

def reference(A_x, A_wqkv, A_wo, B_x, B_w_r, B_w_i):
    def _A_ref(x, wqkv, wo):
        B, S, D = x.shape
        H = 32; Dh = D // H
        qkv = (lambda x, *d: x.permute(*d))((x @ wqkv).reshape(B, S, 3, H, Dh), 2, 0, 3, 1, 4)
        q, k, v = qkv[0], qkv[1], qkv[2]
        phi = lambda t: torch.where(t > 0, t + 1, torch.exp(t)) + 1e-6
        pq, pk = phi(q), phi(k)
        kv = torch.einsum("bhsd,bhse->bhde", pk, v)
        z = torch.einsum("bhsd->bhd", pk)
        num = torch.einsum("bhqd,bhde->bhqe", pq, kv)
        den = torch.einsum("bhqd,bhd->bhq", pq, z)[..., None] + 1e-6
        o = num / den
        return (lambda x, *d: x.permute(*d))(o, 0, 2, 1, 3).reshape(B, S, D) @ wo

    def _B_ref(x, w_r, w_i):
        B, S, D = x.shape
        X = (lambda x, axes=(-2,-1): torch.fft.rfft2(x.float(), dim=axes))(x, axes=(-2, -1))
        W = w_r + 1j * w_i
        X = X * W
        y = (lambda x, s, axes=(-2,-1): torch.fft.irfft2(x, s=s, dim=axes).to(torch.bfloat16))(X, (S, D), axes=(-2, -1))
        return y

    a = _A_ref(A_x, A_wqkv, A_wo)
    b = _B_ref(B_x, B_w_r, B_w_i)
    return torch.concatenate([a, b], axis=-1)
```

```asm
; @launch grid=(512,1,1) block=(256,1,1) lds=81920
.amdgcn_target "amdgcn-amd-amdhsa--gfx950"
.text
.globl concat_heads__linear_attn_block__spectral_gfnet__prompt_kernel
.p2align 8
.type concat_heads__linear_attn_block__spectral_gfnet__prompt_kernel,@function
concat_heads__linear_attn_block__spectral_gfnet__prompt_kernel:
  s_load_dwordx16 s[4:19], s[0:1], 0
  s_load_dwordx2 s[20:21], s[0:1], 64
  s_mov_b32 s68, s2
  s_cmp_lt_u32 s2, 256
  s_cbranch_scc1 role_a
  s_cmp_lt_u32 s2, 512
  s_cbranch_scc1 role_b
  s_endpgm
role_b:
  s_waitcnt lgkmcnt(0)
  s_sub_u32 s2, s2, 256
  v_lshrrev_b32 v1, 6, v0
  s_nop 0
  v_readfirstlane_b32 s40, v1
  v_and_b32 v1, 63, v0
  s_add_u32 s60, s20, 25165824
  s_addc_u32 s61, s21, 0
  s_mov_b32 s62, 49152
  s_mov_b32 s63, 0x00020000
  s_mov_b32 s64, s18
  s_mov_b32 s65, s19
  s_mov_b32 s66, 256
  s_mov_b32 s67, 0x00020000
  v_mov_b32 v17, 0
  v_mov_b32 v18, 1
  v_lshlrev_b32 v2, 4, v1
  s_or_b32 s46, s2, s40
  s_cmp_eq_u32 s46, 0
  s_cbranch_scc0 noclr_1001
  v_mov_b32 v20, 0
  v_mov_b32 v21, 0
  v_mov_b32_e64 v22, 0
  v_mov_b32 v23, 0
  s_mov_b32 s46, 0
  buffer_store_dwordx4 v[20:23], v2, s[60:63], s46 offen offset:0 sc1
  buffer_store_dwordx4 v[20:23], v2, s[60:63], s46 offen offset:1024 sc1
  buffer_store_dwordx4 v[20:23], v2, s[60:63], s46 offen offset:2048 sc1
  buffer_store_dwordx4 v[20:23], v2, s[60:63], s46 offen offset:3072 sc1
  s_mov_b32 s46, 4096
  buffer_store_dwordx4 v[20:23], v2, s[60:63], s46 offen offset:0 sc1
  buffer_store_dwordx4 v[20:23], v2, s[60:63], s46 offen offset:1024 sc1
  buffer_store_dwordx4 v[20:23], v2, s[60:63], s46 offen offset:2048 sc1
  buffer_store_dwordx4 v[20:23], v2, s[60:63], s46 offen offset:3072 sc1
  s_mov_b32 s46, 8192
  buffer_store_dwordx4 v[20:23], v2, s[60:63], s46 offen offset:0 sc1
  buffer_store_dwordx4 v[20:23], v2, s[60:63], s46 offen offset:1024 sc1
  buffer_store_dwordx4 v[20:23], v2, s[60:63], s46 offen offset:2048 sc1
  buffer_store_dwordx4 v[20:23], v2, s[60:63], s46 offen offset:3072 sc1
  s_mov_b32 s46, 12288
  buffer_store_dwordx4 v[20:23], v2, s[60:63], s46 offen offset:0 sc1
  buffer_store_dwordx4 v[20:23], v2, s[60:63], s46 offen offset:1024 sc1
  buffer_store_dwordx4 v[20:23], v2, s[60:63], s46 offen offset:2048 sc1
  buffer_store_dwordx4 v[20:23], v2, s[60:63], s46 offen offset:3072 sc1
noclr_1001:
  s_mov_b32 s24, s10
  s_mov_b32 s25, s11
  s_mov_b32 s26, 4194304
  s_mov_b32 s27, 0x00020000
  s_add_u32 s32, s20, 6291456
  s_addc_u32 s33, s21, 0
  s_mov_b32 s34, 4227072
  s_mov_b32 s35, 0x00020000
  s_add_u32 s36, s20, 16777216
  s_addc_u32 s37, s21, 0
  s_mov_b32 s38, 4202496
  s_mov_b32 s39, 0x00020000
  s_bitcmp1_b32 s40, 0
  s_cselect_b32 s28, s14, s12
  s_cselect_b32 s29, s15, s13
  s_mov_b32 s30, 2101248
  s_mov_b32 s31, 0x00020000
  s_lshr_b32 s41, s2, 5
  s_and_b32 s42, s2, 31
  s_lshl_b32 s43, s41, 2
  s_add_u32 s43, s43, s40
  s_lshl_b32 s43, s43, 5
  s_add_u32 s43, s43, s42
  s_lshl_b32 s43, s43, 12
  s_lshl_b32 m0, s40, 12
  s_nop 0
  buffer_load_dwordx4 v2, s[24:27], s43 offen nt lds
  buffer_load_dwordx4 v2, s[24:27], s43 offen offset:1024 nt lds
  buffer_load_dwordx4 v2, s[24:27], s43 offen offset:2048 nt lds
  buffer_load_dwordx4 v2, s[24:27], s43 offen offset:3072 nt lds
  s_and_b32 s44, s2, 3
  s_bfe_u32 s45, s2, 0x40002
  s_lshr_b32 s46, s2, 6
  s_lshl_b32 s47, s44, 3
  s_lshl_b32 s48, s45, 6
  s_add_u32 s47, s47, s48
  s_lshr_b32 s48, s40, 1
  s_lshl_b32 s48, s48, 10
  s_add_u32 s47, s47, s48
  s_mul_i32 s47, s47, 1026
  s_lshl_b32 s48, s46, 8
  s_add_u32 s49, s47, s48
  v_lshrrev_b32_e64 v20, 4, v1
  v_mul_u32_u24 v21, 1026, v20
  v_and_b32 v22, 1, v20
  v_lshlrev_b32 v22, 2, v22
  v_or_b32 v22, s40, v22
  v_lshlrev_b32 v22, 1, v22
  v_and_b32 v23, 15, v1
  v_xor_b32 v22, v22, v23
  v_lshlrev_b32 v22, 4, v22
  v_add_u32 v3, v21, v22
  s_lshl_b32 s50, s40, 12
  s_add_u32 m0, s50, 16384
  s_nop 0
  buffer_load_dwordx4 v3, s[28:31], s49 offen nt lds
  s_add_u32 s51, s49, 3080
  buffer_load_dwordx4 v3, s[28:31], s51 offen offset:1024 nt lds
  s_add_u32 s51, s49, 30784
  buffer_load_dwordx4 v3, s[28:31], s51 offen offset:2048 nt lds
  s_add_u32 s51, s49, 33864
  buffer_load_dwordx4 v3, s[28:31], s51 offen offset:3072 nt lds
  s_and_b32 s52, s45, 1
  s_lshr_b32 s53, s45, 2
  s_lshl_b32 s53, s53, 1
  s_add_u32 s52, s52, s53
  s_lshl_b32 s52, s52, 10
  s_bfe_u32 s53, s45, 0x10001
  s_lshl_b32 s53, s53, 9
  s_add_u32 s52, s52, s53
  s_lshl_b32 s53, s44, 7
  s_add_u32 s52, s52, s53
  v_and_b32 v20, 7, v1
  v_bfe_u32 v21, v1, 3, 1
  v_lshlrev_b32 v22, 5, v21
  v_add_u32 v22, v22, v20
  v_mul_u32_u24 v22, 1026, v22
  v_add_u32 v4, 1024, v22
  v_lshlrev_b32 v22, 4, v20
  v_lshlrev_b32 v23, 3, v21
  v_add_u32 v16, v22, v23
  s_lshl_b32 s53, s40, 1
  s_add_u32 s53, s53, 57344
  v_add_u32 v5, s53, v16
  s_cmp_eq_u32 s46, 3
  s_cselect_b32 s54, 0xffff, 0
  s_mov_b32 s55, 0
  s_mov_b64 exec, s[54:55]
  buffer_load_ushort v6, v4, s[28:31], s47 offen
  s_mov_b64 exec, -1
  v_and_b32 v22, 31, v1
  v_cvt_f32_u32_e64 v20, v22
  v_mul_f32 v20, 0x3d000000, v20
  v_lshrrev_b32 v22, 5, v1
  v_cvt_f32_u32 v22, v22
  v_mul_f32 v22, 4.0, v22
  v_mul_f32 v21, v22, v20
  v_mov_b32_e64 v136, v21
  v_fmamk_f32 v137, v20, 0x3f800000, v21
  v_fmamk_f32 v138, v20, 0x40000000, v21
  v_fmamk_f32 v139, v20, 0x40400000, v21
  v_fmamk_f32 v140, v20, 0x41000000, v21
  v_fmamk_f32 v141, v20, 0x41100000, v21
  v_fmamk_f32 v142, v20, 0x41200000, v21
  v_fmamk_f32 v143, v20, 0x41300000, v21
  v_fmamk_f32 v144, v20, 0x41800000, v21
  v_fmamk_f32 v145, v20, 0x41880000, v21
  v_fmamk_f32 v146, v20, 0x41900000, v21
  v_fmamk_f32 v147, v20, 0x41980000, v21
  v_fmamk_f32 v148, v20, 0x41c00000, v21
  v_fmamk_f32 v149, v20, 0x41c80000, v21
  v_fmamk_f32 v150, v20, 0x41d00000, v21
  v_fmamk_f32 v151, v20, 0x41d80000, v21
  v_cos_f32 v152, v136
  v_cos_f32 v153, v137
  v_cos_f32 v154, v138
  v_cos_f32 v155, v139
  v_sin_f32 v156, v136
  v_sin_f32 v157, v137
  v_sin_f32 v158, v138
  v_sin_f32 v159, v139
  v_cvt_pk_bf16_f32 v34, v152, v153
  v_cvt_pk_bf16_f32 v35, v154, v155
  v_cvt_pk_bf16_f32 v32, -v156, -v157
  v_cvt_pk_bf16_f32 v33, -v158, -v159
  v_cvt_pk_bf16_f32 v36, v156, v157
  v_cvt_pk_bf16_f32 v37, v158, v159
  v_cos_f32 v152, v140
  v_cos_f32 v153, v141
  v_cos_f32 v154, v142
  v_cos_f32 v155, v143
  v_sin_f32 v156, v140
  v_sin_f32 v157, v141
  v_sin_f32 v158, v142
  v_sin_f32 v159, v143
  v_cvt_pk_bf16_f32 v40, v152, v153
  v_cvt_pk_bf16_f32 v41, v154, v155
  v_cvt_pk_bf16_f32 v38, -v156, -v157
  v_cvt_pk_bf16_f32 v39, -v158, -v159
  v_cvt_pk_bf16_f32 v42, v156, v157
  v_cvt_pk_bf16_f32 v43, v158, v159
  v_cos_f32 v152, v144
  v_cos_f32 v153, v145
  v_cos_f32 v154, v146
  v_cos_f32 v155, v147
  v_sin_f32 v156, v144
  v_sin_f32 v157, v145
  v_sin_f32 v158, v146
  v_sin_f32 v159, v147
  v_cvt_pk_bf16_f32 v46, v152, v153
  v_cvt_pk_bf16_f32 v47, v154, v155
  v_cvt_pk_bf16_f32 v44, -v156, -v157
  v_cvt_pk_bf16_f32 v45, -v158, -v159
  v_cvt_pk_bf16_f32 v48, v156, v157
  v_cvt_pk_bf16_f32 v49, v158, v159
  v_cos_f32 v152, v148
  v_cos_f32 v153, v149
  v_cos_f32 v154, v150
  v_cos_f32 v155, v151
  v_sin_f32 v156, v148
  v_sin_f32 v157, v149
  v_sin_f32 v158, v150
  v_sin_f32 v159, v151
  v_cvt_pk_bf16_f32 v52, v152, v153
  v_cvt_pk_bf16_f32 v53, v154, v155
  v_cvt_pk_bf16_f32 v50, -v156, -v157
  v_cvt_pk_bf16_f32 v51, -v158, -v159
  v_cvt_pk_bf16_f32 v54, v156, v157
  v_cvt_pk_bf16_f32 v55, v158, v159
  v_mul_f32 v136, 0x3d000000, v136
  v_mul_f32 v137, 0x3d000000, v137
  v_mul_f32 v138, 0x3d000000, v138
  v_mul_f32 v139, 0x3d000000, v139
  v_mul_f32 v140, 0x3d000000, v140
  v_mul_f32 v141, 0x3d000000, v141
  v_mul_f32 v142, 0x3d000000, v142
  v_mul_f32 v143, 0x3d000000, v143
  v_mul_f32 v144, 0x3d000000, v144
  v_mul_f32 v145, 0x3d000000, v145
  v_mul_f32 v146, 0x3d000000, v146
  v_mul_f32 v147, 0x3d000000, v147
  v_mul_f32 v148, 0x3d000000, v148
  v_mul_f32 v149, 0x3d000000, v149
  v_mul_f32 v150, 0x3d000000, v150
  v_mul_f32 v151, 0x3d000000, v151
  v_cos_f32 v56, v136
  v_sin_f32 v72, v136
  v_cos_f32 v57, v137
  v_sin_f32 v73, v137
  v_cos_f32 v58, v138
  v_sin_f32 v74, v138
  v_cos_f32 v59, v139
  v_sin_f32 v75, v139
  v_cos_f32 v60, v140
  v_sin_f32 v76, v140
  v_cos_f32 v61, v141
  v_sin_f32 v77, v141
  v_cos_f32 v62, v142
  v_sin_f32 v78, v142
  v_cos_f32 v63, v143
  v_sin_f32 v79, v143
  v_cos_f32 v64, v144
  v_sin_f32 v80, v144
  v_cos_f32 v65, v145
  v_sin_f32 v81, v145
  v_cos_f32 v66, v146
  v_sin_f32 v82, v146
  v_cos_f32 v67, v147
  v_sin_f32 v83, v147
  v_cos_f32 v68, v148
  v_sin_f32 v84, v148
  v_cos_f32 v69, v149
  v_sin_f32 v85, v149
  v_cos_f32 v70, v150
  v_sin_f32 v86, v150
  v_cos_f32_e64 v71, v151
  v_sin_f32 v87, v151
  s_or_b32 s53, s2, s40
  s_cmp_eq_u32 s53, 0
  s_cbranch_scc0 nosig_1002
  s_waitcnt vmcnt(8)
  s_mov_b64 exec, 1
  buffer_store_dword v18, v17, s[64:67], 0 offen sc1
  s_mov_b64 exec, -1
nosig_1002:
  v_lshrrev_b32 v20, 5, v1
  v_lshlrev_b32_e64 v20, 2, v20
  v_bfe_u32 v21, v1, 2, 2
  v_add_u32 v20, v20, v21
  v_lshlrev_b32 v20, 6, v20
  v_bfe_u32 v21, v1, 4, 1
  v_lshlrev_b32 v21, 5, v21
  v_and_b32 v22, 3, v1
  v_lshlrev_b32_e64 v22, 3, v22
  v_add3_u32 v20, v20, v21, v22
  s_lshl_b32 s53, s40, 12
  v_add_u32 v7, s53, v20
  v_lshrrev_b32_e64 v20, 5, v1
  v_mul_u32_u24 v20, 2112, v20
  v_and_b32 v21, 31, v1
  v_lshlrev_b32 v21, 4, v21
  s_lshl_b32 s53, s40, 2
  s_add_u32 s53, s53, 32768
  v_add3_u32 v8, v20, v21, s53
  s_waitcnt vmcnt(4)
  ds_read_b64_tr_b16 v[88:89], v7 offset:0
  ds_read_b64_tr_b16 v[90:91], v7 offset:2048
  ds_read_b64_tr_b16 v[92:93], v7 offset:512
  ds_read_b64_tr_b16 v[94:95], v7 offset:2560
  ds_read_b64_tr_b16 v[96:97], v7 offset:1024
  ds_read_b64_tr_b16 v[98:99], v7 offset:3072
  ds_read_b64_tr_b16 v[100:101], v7 offset:1536
  ds_read_b64_tr_b16 v[102:103], v7 offset:3584
  s_waitcnt lgkmcnt(6)
  v_mfma_f32_32x32x16_bf16 v[104:119], v[88:91], v[34:37], 0
  v_mfma_f32_32x32x16_bf16 v[120:135], v[88:91], v[32:35], 0
  s_waitcnt lgkmcnt(4)
  v_mfma_f32_32x32x16_bf16 v[104:119], v[92:95], v[40:43], v[104:119]
  v_mfma_f32_32x32x16_bf16 v[120:135], v[92:95], v[38:41], v[120:135]
  s_waitcnt lgkmcnt(2)
  v_mfma_f32_32x32x16_bf16 v[104:119], v[96:99], v[46:49], v[104:119]
  v_mfma_f32_32x32x16_bf16 v[120:135], v[96:99], v[44:47], v[120:135]
  s_waitcnt lgkmcnt(0)
  v_mfma_f32_32x32x16_bf16 v[104:119], v[100:103], v[52:55], v[104:119]
  v_mfma_f32_32x32x16_bf16 v[120:135], v[100:103], v[50:53], v[120:135]
  v_and_b32 v20, 7, v0
  v_lshrrev_b32 v21, 3, v0
  v_and_b32 v22, 3, v20
  v_mul_u32_u24 v23, 33, v22
  v_add_u32_e64 v23, v23, v21
  v_sub_u32 v24, 1055, v23
  v_cmp_eq_u32 vcc, 0, v21
  s_nop 1
  v_addc_co_u32 v24, vcc, 0, v24, vcc
  v_cmp_lt_u32 vcc, 3, v20
  s_nop 1
  v_cndmask_b32 v23, v23, v24, vcc
  v_lshlrev_b32_e64 v23, 4, v23
  v_add_u32 v9, 32768, v23
  v_mov_b32 v24, 2112
  v_mov_b32 v25, 4294965184
  v_cndmask_b32 v10, v24, v25, vcc
  v_mov_b32 v24, 0
  v_mov_b32 v25, 0x80000000
  v_cndmask_b32 v11, v24, v25, vcc
  v_cmp_eq_u32 vcc, 4, v0
  v_mov_b32 v24, 32768
  s_nop 0
  v_cndmask_b32 v12, v9, v24, vcc
  v_lshlrev_b32_e64 v13, 4, v0
  s_mul_i32 s56, s2, 16512
  v_pk_mul_f32 v[152:153], v[104:105], v[56:57]
  v_pk_mul_f32 v[154:155], v[120:121], v[56:57]
  v_pk_fma_f32 v[152:153], v[120:121], v[72:73], v[152:153]
  v_pk_fma_f32 v[120:121], v[104:105], v[72:73], v[154:155] neg_lo:[1,0,0] neg_hi:[1,0,0]
  v_cvt_pk_bf16_f32 v88, v152, v153
  v_cvt_pk_bf16_f32 v90, v120, v121
  v_pk_mul_f32 v[156:157], v[106:107], v[58:59]
  v_pk_mul_f32 v[158:159], v[122:123], v[58:59]
  v_pk_fma_f32 v[156:157], v[122:123], v[74:75], v[156:157]
  v_pk_fma_f32 v[122:123], v[106:107], v[74:75], v[158:159] neg_lo:[1,0,0] neg_hi:[1,0,0]
  v_cvt_pk_bf16_f32 v89, v156, v157
  v_cvt_pk_bf16_f32 v91, v122, v123
  v_pk_mul_f32 v[152:153], v[108:109], v[60:61]
  v_pk_mul_f32 v[154:155], v[124:125], v[60:61]
  v_pk_fma_f32 v[152:153], v[124:125], v[76:77], v[152:153]
  v_pk_fma_f32 v[124:125], v[108:109], v[76:77], v[154:155] neg_lo:[1,0,0] neg_hi:[1,0,0]
  v_cvt_pk_bf16_f32 v92, v152, v153
  v_cvt_pk_bf16_f32 v94, v124, v125
  v_pk_mul_f32 v[156:157], v[110:111], v[62:63]
  v_pk_mul_f32 v[158:159], v[126:127], v[62:63]
  v_pk_fma_f32 v[156:157], v[126:127], v[78:79], v[156:157]
  v_pk_fma_f32 v[126:127], v[110:111], v[78:79], v[158:159] neg_lo:[1,0,0] neg_hi:[1,0,0]
  v_cvt_pk_bf16_f32 v93, v156, v157
  v_cvt_pk_bf16_f32 v95, v126, v127
  v_pk_mul_f32 v[152:153], v[112:113], v[64:65]
  v_pk_mul_f32 v[154:155], v[128:129], v[64:65]
  v_pk_fma_f32 v[152:153], v[128:129], v[80:81], v[152:153]
  v_pk_fma_f32 v[128:129], v[112:113], v[80:81], v[154:155] neg_lo:[1,0,0] neg_hi:[1,0,0]
  v_cvt_pk_bf16_f32 v96, v152, v153
  v_cvt_pk_bf16_f32 v98, v128, v129
  v_pk_mul_f32 v[156:157], v[114:115], v[66:67]
  v_pk_mul_f32 v[158:159], v[130:131], v[66:67]
  v_pk_fma_f32 v[156:157], v[130:131], v[82:83], v[156:157]
  v_pk_fma_f32 v[130:131], v[114:115], v[82:83], v[158:159] neg_lo:[1,0,0] neg_hi:[1,0,0]
  v_cvt_pk_bf16_f32 v97, v156, v157
  v_cvt_pk_bf16_f32 v99, v130, v131
  v_pk_mul_f32 v[152:153], v[116:117], v[68:69]
  v_pk_mul_f32 v[154:155], v[132:133], v[68:69]
  v_pk_fma_f32 v[152:153], v[132:133], v[84:85], v[152:153]
  v_pk_fma_f32 v[132:133], v[116:117], v[84:85], v[154:155] neg_lo:[1,0,0] neg_hi:[1,0,0]
  v_cvt_pk_bf16_f32 v100, v152, v153
  v_cvt_pk_bf16_f32 v102, v132, v133
  v_pk_mul_f32 v[156:157], v[118:119], v[70:71]
  v_pk_mul_f32 v[158:159], v[134:135], v[70:71]
  v_pk_fma_f32 v[156:157], v[134:135], v[86:87], v[156:157]
  v_pk_fma_f32 v[134:135], v[118:119], v[86:87], v[158:159] neg_lo:[1,0,0] neg_hi:[1,0,0]
  v_cvt_pk_bf16_f32 v101, v156, v157
  v_cvt_pk_bf16_f32 v103, v134, v135
  v_mfma_f32_32x32x16_bf16 v[104:119], v[34:37], v[88:91], 0
  v_mfma_f32_32x32x16_bf16 v[120:135], v[32:35], v[88:91], 0
  v_mfma_f32_32x32x16_bf16 v[104:119], v[40:43], v[92:95], v[104:119]
  v_mfma_f32_32x32x16_bf16 v[120:135], v[38:41], v[92:95], v[120:135]
  v_mfma_f32_32x32x16_bf16 v[104:119], v[46:49], v[96:99], v[104:119]
  v_mfma_f32_32x32x16_bf16 v[120:135], v[44:47], v[96:99], v[120:135]
  v_mfma_f32_32x32x16_bf16 v[104:119], v[52:55], v[100:103], v[104:119]
  v_mfma_f32_32x32x16_bf16 v[120:135], v[50:53], v[100:103], v[120:135]
  v_bfe_u32 v20, v1, 2, 2
  v_lshrrev_b32 v21, 4, v1
  v_and_b32 v22, 1, v21
  v_lshlrev_b32 v22, 2, v22
  v_or_b32 v22, v22, v20
  s_lshl_b32 s53, s40, 1
  v_xor_b32 v22, s53, v22
  v_lshlrev_b32 v22, 5, v22
  v_lshlrev_b32 v20, 12, v20
  v_lshlrev_b32_e64 v23, 8, v21
  v_add3_u32 v20, v20, v23, v22
  v_and_b32 v23, 3, v1
  v_lshlrev_b32 v23, 3, v23
  v_add_u32 v20, 16384, v20
  v_add_u32 v14, v20, v23
  v_xor_b32 v15, 32, v14
  v_and_b32 v20, 15, v1
  v_lshlrev_b32 v20, 13, v20
  v_lshlrev_b32_e64 v21, 4, v21
  v_add_u32 v3, v20, v21
  s_lshl_b32 s53, s46, 7
  s_lshl_b32 s57, s40, 5
  s_add_u32 s53, s53, s57
  s_lshl_b32 s53, s53, 13
  s_add_u32 s57, s53, s52
  s_add_u32 s58, s57, 131072
  v_cvt_pk_bf16_f32 v88, v104, v120
  ds_write_b32 v8, v88 offset:0
  v_cvt_pk_bf16_f32 v89, v105, v121
  ds_write_b32 v8, v89 offset:528
  v_cvt_pk_bf16_f32 v90, v106, v122
  ds_write_b32 v8, v90 offset:1056
  v_cvt_pk_bf16_f32 v91, v107, v123
  ds_write_b32 v8, v91 offset:1584
  v_cvt_pk_bf16_f32 v92, v108, v124
  ds_write_b32 v8, v92 offset:4224
  v_cvt_pk_bf16_f32 v93, v109, v125
  ds_write_b32 v8, v93 offset:4752
  v_cvt_pk_bf16_f32 v94, v110, v126
  ds_write_b32 v8, v94 offset:5280
  v_cvt_pk_bf16_f32 v95, v111, v127
  ds_write_b32 v8, v95 offset:5808
  v_cvt_pk_bf16_f32 v96, v112, v128
  ds_write_b32 v8, v96 offset:8448
  v_cvt_pk_bf16_f32 v97, v113, v129
  ds_write_b32 v8, v97 offset:8976
  v_cvt_pk_bf16_f32 v98, v114, v130
  ds_write_b32 v8, v98 offset:9504
  v_cvt_pk_bf16_f32 v99, v115, v131
  ds_write_b32 v8, v99 offset:10032
  v_cvt_pk_bf16_f32 v100, v116, v132
  ds_write_b32 v8, v100 offset:12672
  v_cvt_pk_bf16_f32 v101, v117, v133
  ds_write_b32 v8, v101 offset:13200
  v_cvt_pk_bf16_f32 v102, v118, v134
  ds_write_b32 v8, v102 offset:13728
  v_cvt_pk_bf16_f32 v103, v119, v135
  ds_write_b32 v8, v103 offset:14256
  s_mov_b64 exec, 0xffff
  s_waitcnt vmcnt(0)
  ds_write_b16 v5, v6
  s_mov_b64 exec, -1
  s_waitcnt lgkmcnt(0)
  s_barrier
  ds_read_b64_tr_b16 v[136:137], v14 offset:0
  ds_read_b64_tr_b16 v[138:139], v14 offset:2048
  ds_read_b64_tr_b16 v[140:141], v14 offset:1024
  ds_read_b64_tr_b16 v[142:143], v14 offset:3072
  ds_read_b64_tr_b16 v[144:145], v15 offset:0
  ds_read_b64_tr_b16 v[146:147], v15 offset:2048
  ds_read_b64_tr_b16 v[148:149], v15 offset:1024
  ds_read_b64_tr_b16 v[150:151], v15 offset:3072
  ds_read_b128 v[152:155], v12
  v_add_u32_e64 v9, v9, v10
  ds_read_b128 v[156:159], v9
  v_add_u32_e64 v9, v9, v10
  ds_read_b128 v[160:163], v9
  v_add_u32_e64 v9, v9, v10
  ds_read_b128 v[164:167], v9
  v_add_u32_e64 v9, v9, v10
  ds_read_b128 v[168:171], v9
  ds_read_b64 v[172:173], v16 offset:57344
  v_and_b32 v20, 15, v1
  v_lshrrev_b32 v21, 4, v1
  v_and_b32 v22, 7, v1
  v_xor_b32 v21, v21, v22
  v_lshlrev_b32_e64 v21, 4, v21
  v_lshlrev_b32 v20, 7, v20
  s_lshl_b32 s53, s40, 12
  s_add_u32 s53, s53, 61440
  v_add3_u32 v20, v20, v21, s53
  v_xor_b32 v21, 64, v20
  v_lshrrev_b32 v22, 3, v1
  v_and_b32 v23, 7, v1
  v_xor_b32 v24, v22, v23
  v_lshlrev_b32 v24, 4, v24
  v_lshlrev_b32 v25, 7, v22
  v_add3_u32 v24, v24, v25, s53
  v_lshlrev_b32 v22, 13, v22
  v_lshlrev_b32 v23, 4, v23
  v_add_u32_e64 v3, v22, v23
  s_waitcnt lgkmcnt(12)
  ds_write_b128 v20, v[136:139]
  s_waitcnt lgkmcnt(11)
  ds_write_b128 v21, v[140:143]
  s_waitcnt lgkmcnt(10)
  ds_write_b128 v20, v[144:147] offset:2048
  s_waitcnt lgkmcnt(9)
  ds_write_b128 v21, v[148:151] offset:2048
  ds_read_b128 v[88:91], v24
  ds_read_b128 v[92:95], v24 offset:1024
  ds_read_b128 v[96:99], v24 offset:2048
  ds_read_b128 v[100:103], v24 offset:3072
  s_waitcnt lgkmcnt(13)
  v_xor_b32 v152, v11, v152
  v_xor_b32 v153, v11, v153
  v_xor_b32 v154, v11, v154
  v_xor_b32_e64 v155, v11, v155
  buffer_store_dwordx4 v[152:155], v13, s[32:35], s56 offen sc1
  s_add_u32 s56, s56, 4096
  s_waitcnt lgkmcnt(12)
  v_xor_b32 v156, v11, v156
  v_xor_b32 v157, v11, v157
  v_xor_b32 v158, v11, v158
  v_xor_b32_e64 v159, v11, v159
  buffer_store_dwordx4 v[156:159], v13, s[32:35], s56 offen sc1
  s_add_u32 s56, s56, 4096
  s_waitcnt lgkmcnt(11)
  v_xor_b32 v160, v11, v160
  v_xor_b32 v161, v11, v161
  v_xor_b32 v162, v11, v162
  v_xor_b32_e64 v163, v11, v163
  buffer_store_dwordx4 v[160:163], v13, s[32:35], s56 offen sc1
  s_add_u32 s56, s56, 4096
  s_waitcnt lgkmcnt(10)
  v_xor_b32 v164, v11, v164
  v_xor_b32 v165, v11, v165
  v_xor_b32 v166, v11, v166
  v_xor_b32_e64 v167, v11, v167
  buffer_store_dwordx4 v[164:167], v13, s[32:35], s56 offen sc1
  s_add_u32 s56, s56, 4096
  s_waitcnt lgkmcnt(9)
  v_xor_b32 v168, v11, v168
  v_xor_b32 v169, v11, v169
  v_xor_b32 v170, v11, v170
  v_xor_b32 v171, v11, v171
  s_cmp_eq_u32 s40, 0
  s_cselect_b32 s54, 0xff, 0
  s_mov_b32 s55, 0
  s_mov_b64 exec, s[54:55]
  buffer_store_dwordx4 v[168:171], v13, s[32:35], s56 offen sc1
  s_add_u32 s56, s56, 4096
  s_mov_b64 exec, -1
  s_waitcnt lgkmcnt(3)
  buffer_store_dwordx4 v[88:91], v3, s[36:39], s57 offen sc1
  s_add_u32 s57, s57, 65536
  s_waitcnt lgkmcnt(2)
  buffer_store_dwordx4 v[92:95], v3, s[36:39], s57 offen sc1
  s_add_u32 s57, s57, 65536
  s_waitcnt lgkmcnt(1)
  buffer_store_dwordx4 v[96:99], v3, s[36:39], s57 offen sc1
  s_add_u32 s57, s57, 65536
  s_waitcnt lgkmcnt(0)
  buffer_store_dwordx4 v[100:103], v3, s[36:39], s57 offen sc1
  s_cmp_eq_u32 s46, 3
  s_cselect_b32 s54, 0xffff, 0
  s_cmp_eq_u32 s40, 0
  s_cselect_b32 s54, s54, 0
  s_add_u32 s53, s52, 4194304
  s_mov_b32 s55, 0
  s_mov_b64 exec, s[54:55]
  buffer_store_dwordx2 v[172:173], v16, s[36:39], s53 offen sc1
  s_mov_b64 exec, -1
  buffer_load_dword v19, v17, s[64:67], 0 offen sc1
  v_and_b32 v30, 31, v1
  v_cvt_f32_u32_e64 v28, v30
  v_mul_f32 v28, 0x3d000000, v28
  v_lshrrev_b32 v30, 5, v1
  v_cvt_f32_u32 v30, v30
  v_mul_f32 v30, 4.0, v30
  v_mul_f32 v29, v30, v28
  v_mov_b32_e64 v192, v29
  v_fmamk_f32 v193, v28, 0x3f800000, v29
  v_fmamk_f32 v194, v28, 0x40000000, v29
  v_fmamk_f32 v195, v28, 0x40400000, v29
  v_fmamk_f32 v196, v28, 0x41000000, v29
  v_fmamk_f32 v197, v28, 0x41100000, v29
  v_fmamk_f32 v198, v28, 0x41200000, v29
  v_fmamk_f32 v199, v28, 0x41300000, v29
  v_fmamk_f32 v200, v28, 0x41800000, v29
  v_fmamk_f32 v201, v28, 0x41880000, v29
  v_fmamk_f32 v202, v28, 0x41900000, v29
  v_fmamk_f32 v203, v28, 0x41980000, v29
  v_fmamk_f32 v204, v28, 0x41c00000, v29
  v_fmamk_f32 v205, v28, 0x41c80000, v29
  v_fmamk_f32 v206, v28, 0x41d00000, v29
  v_fmamk_f32 v207, v28, 0x41d80000, v29
  v_cos_f32 v20, v192
  v_cos_f32 v21, v193
  v_cos_f32 v22, v194
  v_cos_f32 v23, v195
  v_sin_f32 v24, v192
  v_sin_f32 v25, v193
  v_sin_f32 v26, v194
  v_sin_f32 v27, v195
  v_cvt_pk_bf16_f32 v32, v20, v24
  v_cvt_pk_bf16_f32 v48, -v24, v20
  v_cvt_pk_bf16_f32 v33, v21, v25
  v_cvt_pk_bf16_f32 v49, -v25, v21
  v_cvt_pk_bf16_f32 v34, v22, v26
  v_cvt_pk_bf16_f32 v50, -v26, v22
  v_cvt_pk_bf16_f32 v35, v23, v27
  v_cvt_pk_bf16_f32 v51, -v27, v23
  v_cos_f32 v20, v196
  v_cos_f32 v21, v197
  v_cos_f32 v22, v198
  v_cos_f32 v23, v199
  v_sin_f32 v24, v196
  v_sin_f32 v25, v197
  v_sin_f32 v26, v198
  v_sin_f32 v27, v199
  v_cvt_pk_bf16_f32 v36, v20, v24
  v_cvt_pk_bf16_f32 v52, -v24, v20
  v_cvt_pk_bf16_f32 v37, v21, v25
  v_cvt_pk_bf16_f32 v53, -v25, v21
  v_cvt_pk_bf16_f32 v38, v22, v26
  v_cvt_pk_bf16_f32 v54, -v26, v22
  v_cvt_pk_bf16_f32 v39, v23, v27
  v_cvt_pk_bf16_f32 v55, -v27, v23
  v_cos_f32 v20, v200
  v_cos_f32 v21, v201
  v_cos_f32 v22, v202
  v_cos_f32 v23, v203
  v_sin_f32 v24, v200
  v_sin_f32 v25, v201
  v_sin_f32 v26, v202
  v_sin_f32 v27, v203
  v_cvt_pk_bf16_f32 v40, v20, v24
  v_cvt_pk_bf16_f32 v56, -v24, v20
  v_cvt_pk_bf16_f32 v41, v21, v25
  v_cvt_pk_bf16_f32 v57, -v25, v21
  v_cvt_pk_bf16_f32 v42, v22, v26
  v_cvt_pk_bf16_f32 v58, -v26, v22
  v_cvt_pk_bf16_f32 v43, v23, v27
  v_cvt_pk_bf16_f32 v59, -v27, v23
  v_cos_f32 v20, v204
  v_cos_f32 v21, v205
  v_cos_f32 v22, v206
  v_cos_f32 v23, v207
  v_sin_f32 v24, v204
  v_sin_f32 v25, v205
  v_sin_f32 v26, v206
  v_sin_f32 v27, v207
  v_cvt_pk_bf16_f32 v44, v20, v24
  v_cvt_pk_bf16_f32 v60, -v24, v20
  v_cvt_pk_bf16_f32 v45, v21, v25
  v_cvt_pk_bf16_f32 v61, -v25, v21
  v_cvt_pk_bf16_f32 v46, v22, v26
  v_cvt_pk_bf16_f32 v62, -v26, v22
  v_cvt_pk_bf16_f32 v47, v23, v27
  v_cvt_pk_bf16_f32 v63, -v27, v23
  v_mul_f32 v192, 0x3d000000, v192
  v_mul_f32 v193, 0x3d000000, v193
  v_mul_f32 v194, 0x3d000000, v194
  v_mul_f32 v195, 0x3d000000, v195
  v_mul_f32 v196, 0x3d000000, v196
  v_mul_f32 v197, 0x3d000000, v197
  v_mul_f32 v198, 0x3d000000, v198
  v_mul_f32 v199, 0x3d000000, v199
  v_mul_f32 v200, 0x3d000000, v200
  v_mul_f32 v201, 0x3d000000, v201
  v_mul_f32 v202, 0x3d000000, v202
  v_mul_f32 v203, 0x3d000000, v203
  v_mul_f32 v204, 0x3d000000, v204
  v_mul_f32 v205, 0x3d000000, v205
  v_mul_f32 v206, 0x3d000000, v206
  v_mul_f32 v207, 0x3d000000, v207
  v_cos_f32 v64, v192
  v_sin_f32 v80, v192
  v_cos_f32 v65, v193
  v_sin_f32 v81, v193
  v_cos_f32 v66, v194
  v_sin_f32 v82, v194
  v_cos_f32 v67, v195
  v_sin_f32 v83, v195
  v_cos_f32 v68, v196
  v_sin_f32 v84, v196
  v_cos_f32 v69, v197
  v_sin_f32 v85, v197
  v_cos_f32 v70, v198
  v_sin_f32 v86, v198
  v_cos_f32 v71, v199
  v_sin_f32 v87, v199
  v_cos_f32 v72, v200
  v_sin_f32 v88, v200
  v_cos_f32 v73, v201
  v_sin_f32 v89, v201
  v_cos_f32 v74, v202
  v_sin_f32 v90, v202
  v_cos_f32 v75, v203
  v_sin_f32 v91, v203
  v_cos_f32 v76, v204
  v_sin_f32 v92, v204
  v_cos_f32 v77, v205
  v_sin_f32 v93, v205
  v_cos_f32 v78, v206
  v_sin_f32 v94, v206
  v_cos_f32_e64 v79, v207
  v_sin_f32 v95, v207
  s_lshl_b32 s69, s2, 4
  s_add_u32 s69, s69, 8192
  s_waitcnt vmcnt(0)
  s_barrier
  s_cmp_eq_u32 s40, 0
  s_cbranch_scc0 w0_1003
  v_cmp_eq_u32 vcc, 0, v19
  s_cbranch_vccz ok_1004
  s_mov_b32 s59, 40000
spin_1005:
  s_sleep 1
  buffer_load_dword v19, v17, s[64:67], 0 offen sc1
  s_waitcnt vmcnt(0)
  v_cmp_eq_u32 vcc, 0, v19
  s_cbranch_vccz ok_1004
  s_sub_u32 s59, s59, 1
  s_cmp_lg_u32 s59, 0
  s_cbranch_scc1 spin_1005
ok_1004:
  s_mov_b64 exec, 1
  v_mov_b32 v19, 1
  s_mov_b32 s69, 8192
  buffer_atomic_add v19, v17, s[60:63], s69 offen sc0
  s_waitcnt vmcnt(0)
  v_cmp_eq_u32 vcc, 255, v19
  s_cbranch_vccz nogo_1006
  buffer_store_dword v18, v17, s[60:63], s69 offen offset:256 sc1
nogo_1006:
  s_mov_b64 exec, -1
w0_1003:
  s_cmp_lt_u32 s2, 129
  s_cbranch_scc0 b3_1007
  s_add_u32 s24, s20, 6291456
  s_addc_u32 s25, s21, 0
  s_mov_b32 s26, 4227072
  s_mov_b32 s27, 0x00020000
  s_add_u32 s28, s20, 16777216
  s_addc_u32 s29, s21, 0
  s_mov_b32 s30, 4202496
  s_mov_b32 s31, 0x00020000
  s_add_u32 s32, s20, 11534336
  s_addc_u32 s33, s21, 0
  s_mov_b32 s34, 4227072
  s_mov_b32 s35, 0x00020000
  v_lshrrev_b32_e64 v20, 3, v1
  v_mul_u32_u24 v20, 16512, v20
  v_lshrrev_b32 v21, 4, v1
  v_and_b32 v22, 7, v1
  v_xor_b32 v21, v21, v22
  v_lshlrev_b32 v21, 4, v21
  v_add_u32 v2, v20, v21
  v_xor_b32 v21, 64, v21
  v_add_u32_e64 v3, v20, v21
  s_mul_i32 s41, s40, 1056768
  s_lshl_b32 s42, s2, 7
  s_add_u32 s41, s41, s42
  s_lshl_b32 s43, s40, 13
  v_lshlrev_b32 v4, 4, v1
  v_add_u32 v11, s43, v4
  s_and_b32 s44, s2, 31
  s_lshr_b32 s45, s2, 5
  s_lshl_b32 s46, s45, 2
  s_add_u32 s46, s46, s40
  s_lshl_b32 s46, s46, 5
  s_add_u32 s48, s46, s44
  s_lshl_b32 s49, s48, 13
  v_and_b32 v20, 31, v1
  v_cvt_f32_u32 v20, v20
  v_mul_f32 v20, 0x3a000000, v20
  v_lshrrev_b32 v21, 5, v1
  v_cvt_f32_u32 v21, v21
  v_fmamk_f32 v20, v21, 0x3d800000, v20
  v_mov_b32_e64 v192, v20
  v_add_f32 v193, 0x3c800000, v20
  v_add_f32 v194, 0x3d000000, v20
  v_add_f32 v195, 0x3d400000, v20
  v_add_f32 v196, 0x3e000000, v20
  v_add_f32 v197, 0x3e100000, v20
  v_add_f32 v198, 0x3e200000, v20
  v_add_f32 v199, 0x3e300000, v20
  v_add_f32 v200, 0x3e800000, v20
  v_add_f32 v201, 0x3e880000, v20
  v_add_f32 v202, 0x3e900000, v20
  v_add_f32 v203, 0x3e980000, v20
  v_add_f32 v204, 0x3ec00000, v20
  v_add_f32 v205, 0x3ec80000, v20
  v_add_f32 v206, 0x3ed00000, v20
  v_add_f32 v207, 0x3ed80000, v20
  v_cos_f32 v96, v192
  v_sin_f32 v112, v192
  v_cos_f32 v97, v193
  v_sin_f32 v113, v193
  v_cos_f32 v98, v194
  v_sin_f32 v114, v194
  v_cos_f32 v99, v195
  v_sin_f32 v115, v195
  v_cos_f32 v100, v196
  v_sin_f32 v116, v196
  v_cos_f32 v101, v197
  v_sin_f32 v117, v197
  v_cos_f32 v102, v198
  v_sin_f32 v118, v198
  v_cos_f32 v103, v199
  v_sin_f32 v119, v199
  v_cos_f32 v104, v200
  v_sin_f32 v120, v200
  v_cos_f32 v105, v201
  v_sin_f32 v121, v201
  v_cos_f32 v106, v202
  v_sin_f32 v122, v202
  v_cos_f32 v107, v203
  v_sin_f32 v123, v203
  v_cos_f32 v108, v204
  v_sin_f32 v124, v204
  v_cos_f32 v109, v205
  v_sin_f32 v125, v205
  v_cos_f32 v110, v206
  v_sin_f32 v126, v206
  v_cos_f32 v111, v207
  v_sin_f32 v127, v207
  v_lshlrev_b32_e64 v20, 7, v1
  v_bfe_u32 v21, v1, 1, 3
  v_xor_b32 v21, s40, v21
  v_lshlrev_b32 v21, 4, v21
  v_add_u32 v5, v20, v21
  v_xor_b32 v6, 64, v5
  v_mul_u32_u24 v20, 144, v1
  s_lshl_b32 s50, s40, 2
  s_add_u32 s50, s50, 32768
  v_add_u32 v7, s50, v20
  s_sub_u32 s51, 3, s40
  s_sub_u32 s52, 4, s40
  s_and_b32 s52, s52, 3
  s_cmp_eq_u32 s44, 0
  s_cselect_b32 s51, s52, s51
  s_lshl_b32 s51, s51, 2
  s_add_u32 s51, s51, 32784
  v_add_u32 v8, s51, v20
  v_lshrrev_b32 v20, 3, v0
  v_and_b32 v21, 7, v0
  v_lshlrev_b32 v21, 4, v21
  v_mul_u32_u24 v22, 144, v20
  v_add_u32 v22, 32768, v22
  v_add_u32_e64 v9, v22, v21
  v_mul_u32_u24 v22, 16512, v20
  v_add_u32 v10, v22, v21
  s_lshl_b32 s53, s2, 7
  s_mov_b32 s58, 8192
  s_cmp_eq_u32 s40, 0
  s_cbranch_scc0 w0_1009
  s_mov_b32 s59, 40000
spin_1011:
  buffer_load_dword v20, v17, s[60:63], s58 offen offset:256 sc1
  s_waitcnt vmcnt(0)
  v_cmp_ne_u32_e64 vcc, 1, v20
  s_cbranch_vccz ok_1010
  s_sleep 4
  s_sub_u32 s59, s59, 1
  s_cmp_lg_u32 s59, 0
  s_cbranch_scc1 spin_1011
ok_1010:
w0_1009:
  s_barrier
  s_setprio 0
  buffer_load_dwordx4 v[224:227], v2, s[24:27], s41 offen sc1
  s_add_u32 s41, s41, 132096
  buffer_load_dwordx4 v[228:231], v3, s[24:27], s41 offen sc1
  s_add_u32 s41, s41, 132096
  buffer_load_dwordx4 v[232:235], v2, s[24:27], s41 offen sc1
  s_add_u32 s41, s41, 132096
  buffer_load_dwordx4 v[236:239], v3, s[24:27], s41 offen sc1
  s_add_u32 s41, s41, 132096
  buffer_load_dwordx4 v[240:243], v2, s[24:27], s41 offen sc1
  s_add_u32 s41, s41, 132096
  buffer_load_dwordx4 v[244:247], v3, s[24:27], s41 offen sc1
  s_add_u32 s41, s41, 132096
  buffer_load_dwordx4 v[248:251], v2, s[24:27], s41 offen sc1
  s_add_u32 s41, s41, 132096
  buffer_load_dwordx4 v[252:255], v3, s[24:27], s41 offen sc1
  buffer_load_dwordx4 v[128:131], v4, s[28:31], s49 offen sc1
  buffer_load_dwordx4 v[132:135], v4, s[28:31], s49 offen offset:1024 sc1
  buffer_load_dwordx4 v[136:139], v4, s[28:31], s49 offen offset:2048 sc1
  buffer_load_dwordx4 v[140:143], v4, s[28:31], s49 offen offset:3072 sc1
  s_add_u32 s49, s49, 4096
  buffer_load_dwordx4 v[144:147], v4, s[28:31], s49 offen sc1
  buffer_load_dwordx4 v[148:151], v4, s[28:31], s49 offen offset:1024 sc1
  buffer_load_dwordx4 v[152:155], v4, s[28:31], s49 offen offset:2048 sc1
  buffer_load_dwordx4 v[156:159], v4, s[28:31], s49 offen offset:3072 sc1
  s_waitcnt vmcnt(15)
  ds_write_b128 v11, v[224:227] offset:0
  s_waitcnt vmcnt(14)
  ds_write_b128 v11, v[228:231] offset:1024
  s_waitcnt vmcnt(13)
  ds_write_b128 v11, v[232:235] offset:2048
  s_waitcnt vmcnt(12)
  ds_write_b128 v11, v[236:239] offset:3072
  s_waitcnt vmcnt(11)
  ds_write_b128 v11, v[240:243] offset:4096
  s_waitcnt vmcnt(10)
  ds_write_b128 v11, v[244:247] offset:5120
  s_waitcnt vmcnt(9)
  ds_write_b128 v11, v[248:251] offset:6144
  s_waitcnt vmcnt(8)
  ds_write_b128 v11, v[252:255] offset:7168
  s_waitcnt lgkmcnt(0)
  s_barrier
  ds_read_b128 v[160:163], v5 offset:0
  ds_read_b128 v[164:167], v5 offset:8192
  ds_read_b128 v[168:171], v5 offset:16384
  ds_read_b128 v[172:175], v5 offset:24576
  ds_read_b128 v[176:179], v6 offset:0
  ds_read_b128 v[180:183], v6 offset:8192
  ds_read_b128 v[184:187], v6 offset:16384
  ds_read_b128 v[188:191], v6 offset:24576
  s_setprio 0
  s_waitcnt lgkmcnt(7)
  v_mfma_f32_32x32x16_bf16 v[192:207], v[160:163], v[32:35], 0
  v_mfma_f32_32x32x16_bf16 v[208:223], v[160:163], v[48:51], 0
  s_waitcnt lgkmcnt(6)
  v_mfma_f32_32x32x16_bf16 v[192:207], v[164:167], v[36:39], v[192:207]
  v_mfma_f32_32x32x16_bf16 v[208:223], v[164:167], v[52:55], v[208:223]
  s_waitcnt lgkmcnt(5)
  v_mfma_f32_32x32x16_bf16 v[192:207], v[168:171], v[40:43], v[192:207]
  v_mfma_f32_32x32x16_bf16 v[208:223], v[168:171], v[56:59], v[208:223]
  s_waitcnt lgkmcnt(4)
  v_mfma_f32_32x32x16_bf16 v[192:207], v[172:175], v[44:47], v[192:207]
  v_mfma_f32_32x32x16_bf16 v[208:223], v[172:175], v[60:63], v[208:223]
  s_waitcnt lgkmcnt(3)
  v_mfma_f32_32x32x16_bf16 v[224:239], v[176:179], v[32:35], 0
  v_mfma_f32_32x32x16_bf16 v[240:255], v[176:179], v[48:51], 0
  s_waitcnt lgkmcnt(2)
  v_mfma_f32_32x32x16_bf16 v[224:239], v[180:183], v[36:39], v[224:239]
  s_nop 5
  v_pk_mul_f32 v[20:21], v[192:193], v[64:65]
  v_pk_mul_f32 v[22:23], v[208:209], v[64:65]
  v_pk_fma_f32 v[20:21], v[208:209], v[80:81], v[20:21]
  v_pk_fma_f32 v[22:23], v[192:193], v[80:81], v[22:23] neg_lo:[1,0,0] neg_hi:[1,0,0]
  v_cvt_pk_bf16_f32 v160, v20, v22
  v_cvt_pk_bf16_f32 v161, v21, v23
  v_pk_mul_f32 v[24:25], v[194:195], v[66:67]
  v_pk_mul_f32 v[26:27], v[210:211], v[66:67]
  v_mfma_f32_32x32x16_bf16 v[240:255], v[180:183], v[52:55], v[240:255]
  v_pk_fma_f32 v[24:25], v[210:211], v[82:83], v[24:25]
  v_pk_fma_f32 v[26:27], v[194:195], v[82:83], v[26:27] neg_lo:[1,0,0] neg_hi:[1,0,0]
  v_cvt_pk_bf16_f32 v162, v24, v26
  v_cvt_pk_bf16_f32 v163, v25, v27
  v_pk_mul_f32 v[20:21], v[196:197], v[68:69]
  v_pk_mul_f32 v[22:23], v[212:213], v[68:69]
  v_pk_fma_f32 v[20:21], v[212:213], v[84:85], v[20:21]
  v_pk_fma_f32 v[22:23], v[196:197], v[84:85], v[22:23] neg_lo:[1,0,0] neg_hi:[1,0,0]
	s_nop 0
  s_waitcnt lgkmcnt(1)
  v_mfma_f32_32x32x16_bf16 v[224:239], v[184:187], v[40:43], v[224:239]
  v_cvt_pk_bf16_f32 v164, v20, v22
  v_cvt_pk_bf16_f32 v165, v21, v23
  v_pk_mul_f32 v[24:25], v[198:199], v[70:71]
  v_pk_mul_f32 v[26:27], v[214:215], v[70:71]
  v_pk_fma_f32 v[24:25], v[214:215], v[86:87], v[24:25]
  v_pk_fma_f32 v[26:27], v[198:199], v[86:87], v[26:27] neg_lo:[1,0,0] neg_hi:[1,0,0]
  v_cvt_pk_bf16_f32 v166, v24, v26
  v_cvt_pk_bf16_f32 v167, v25, v27
  v_mfma_f32_32x32x16_bf16 v[240:255], v[184:187], v[56:59], v[240:255]
  v_pk_mul_f32 v[20:21], v[200:201], v[72:73]
  v_pk_mul_f32 v[22:23], v[216:217], v[72:73]
  v_pk_fma_f32 v[20:21], v[216:217], v[88:89], v[20:21]
  v_pk_fma_f32 v[22:23], v[200:201], v[88:89], v[22:23] neg_lo:[1,0,0] neg_hi:[1,0,0]
  v_cvt_pk_bf16_f32 v168, v20, v22
  v_cvt_pk_bf16_f32 v169, v21, v23
  v_pk_mul_f32 v[24:25], v[202:203], v[74:75]
  v_pk_mul_f32 v[26:27], v[218:219], v[74:75]
	s_nop 0
  s_waitcnt lgkmcnt(0)
  v_mfma_f32_32x32x16_bf16 v[224:239], v[188:191], v[44:47], v[224:239]
  v_pk_fma_f32 v[24:25], v[218:219], v[90:91], v[24:25]
  v_pk_fma_f32 v[26:27], v[202:203], v[90:91], v[26:27] neg_lo:[1,0,0] neg_hi:[1,0,0]
  v_cvt_pk_bf16_f32 v170, v24, v26
  v_cvt_pk_bf16_f32 v171, v25, v27
  v_pk_mul_f32 v[20:21], v[204:205], v[76:77]
  v_pk_mul_f32 v[22:23], v[220:221], v[76:77]
  v_pk_fma_f32 v[20:21], v[220:221], v[92:93], v[20:21]
  v_pk_fma_f32 v[22:23], v[204:205], v[92:93], v[22:23] neg_lo:[1,0,0] neg_hi:[1,0,0]
  v_mfma_f32_32x32x16_bf16 v[240:255], v[188:191], v[60:63], v[240:255]
  v_cvt_pk_bf16_f32 v172, v20, v22
  v_cvt_pk_bf16_f32 v173, v21, v23
  v_pk_mul_f32 v[24:25], v[206:207], v[78:79]
  v_pk_mul_f32 v[26:27], v[222:223], v[78:79]
  v_pk_fma_f32 v[24:25], v[222:223], v[94:95], v[24:25]
  v_pk_fma_f32 v[26:27], v[206:207], v[94:95], v[26:27] neg_lo:[1,0,0] neg_hi:[1,0,0]
  v_cvt_pk_bf16_f32 v174, v24, v26
  v_cvt_pk_bf16_f32 v175, v25, v27
  v_mfma_f32_32x32x16_bf16 v[192:207], v[32:35], v[160:163], 0
  v_mfma_f32_32x32x16_bf16 v[208:223], v[48:51], v[160:163], 0
  v_pk_mul_f32 v[20:21], v[224:225], v[64:65]
	s_nop 0
  s_nop 0
  v_pk_mul_f32 v[22:23], v[240:241], v[64:65]
  v_pk_fma_f32 v[20:21], v[240:241], v[80:81], v[20:21]
  v_pk_fma_f32 v[22:23], v[224:225], v[80:81], v[22:23] neg_lo:[1,0,0] neg_hi:[1,0,0]
  v_cvt_pk_bf16_f32 v176, v20, v22
  v_cvt_pk_bf16_f32 v177, v21, v23
  v_pk_mul_f32 v[24:25], v[226:227], v[66:67]
  v_mfma_f32_32x32x16_bf16 v[192:207], v[36:39], v[164:167], v[192:207]
  v_pk_mul_f32 v[26:27], v[242:243], v[66:67]
  v_pk_fma_f32 v[24:25], v[242:243], v[82:83], v[24:25]
  v_pk_fma_f32 v[26:27], v[226:227], v[82:83], v[26:27] neg_lo:[1,0,0] neg_hi:[1,0,0]
  v_cvt_pk_bf16_f32 v178, v24, v26
  v_cvt_pk_bf16_f32 v179, v25, v27
  v_pk_mul_f32 v[20:21], v[228:229], v[68:69]
  v_pk_mul_f32 v[22:23], v[244:245], v[68:69]
  v_mfma_f32_32x32x16_bf16 v[208:223], v[52:55], v[164:167], v[208:223]
  v_pk_fma_f32 v[20:21], v[244:245], v[84:85], v[20:21]
  v_pk_fma_f32 v[22:23], v[228:229], v[84:85], v[22:23] neg_lo:[1,0,0] neg_hi:[1,0,0]
  v_cvt_pk_bf16_f32 v180, v20, v22
  v_cvt_pk_bf16_f32 v181, v21, v23
  v_pk_mul_f32 v[24:25], v[230:231], v[70:71]
  v_pk_mul_f32 v[26:27], v[246:247], v[70:71]
  v_pk_fma_f32 v[24:25], v[246:247], v[86:87], v[24:25]
  v_mfma_f32_32x32x16_bf16 v[192:207], v[40:43], v[168:171], v[192:207]
  v_pk_fma_f32 v[26:27], v[230:231], v[86:87], v[26:27] neg_lo:[1,0,0] neg_hi:[1,0,0]
  v_cvt_pk_bf16_f32 v182, v24, v26
  v_cvt_pk_bf16_f32 v183, v25, v27
  v_pk_mul_f32 v[20:21], v[232:233], v[72:73]
  v_pk_mul_f32 v[22:23], v[248:249], v[72:73]
  v_pk_fma_f32 v[20:21], v[248:249], v[88:89], v[20:21]
  v_pk_fma_f32 v[22:23], v[232:233], v[88:89], v[22:23] neg_lo:[1,0,0] neg_hi:[1,0,0]
  v_mfma_f32_32x32x16_bf16 v[208:223], v[56:59], v[168:171], v[208:223]
  v_cvt_pk_bf16_f32 v184, v20, v22
  v_cvt_pk_bf16_f32 v185, v21, v23
  v_pk_mul_f32 v[24:25], v[234:235], v[74:75]
  v_pk_mul_f32 v[26:27], v[250:251], v[74:75]
  v_pk_fma_f32 v[24:25], v[250:251], v[90:91], v[24:25]
  v_pk_fma_f32 v[26:27], v[234:235], v[90:91], v[26:27] neg_lo:[1,0,0] neg_hi:[1,0,0]
  v_cvt_pk_bf16_f32 v186, v24, v26
  v_mfma_f32_32x32x16_bf16 v[192:207], v[44:47], v[172:175], v[192:207]
  v_cvt_pk_bf16_f32 v187, v25, v27
  v_pk_mul_f32 v[20:21], v[236:237], v[76:77]
  v_pk_mul_f32 v[22:23], v[252:253], v[76:77]
  v_pk_fma_f32 v[20:21], v[252:253], v[92:93], v[20:21]
  v_pk_fma_f32 v[22:23], v[236:237], v[92:93], v[22:23] neg_lo:[1,0,0] neg_hi:[1,0,0]
  v_cvt_pk_bf16_f32 v188, v20, v22
  v_cvt_pk_bf16_f32 v189, v21, v23
  v_mfma_f32_32x32x16_bf16 v[208:223], v[60:63], v[172:175], v[208:223]
  v_pk_mul_f32 v[24:25], v[238:239], v[78:79]
  v_pk_mul_f32 v[26:27], v[254:255], v[78:79]
  v_pk_fma_f32 v[24:25], v[254:255], v[94:95], v[24:25]
  v_pk_fma_f32 v[26:27], v[238:239], v[94:95], v[26:27] neg_lo:[1,0,0] neg_hi:[1,0,0]
  v_cvt_pk_bf16_f32 v190, v24, v26
  v_cvt_pk_bf16_f32 v191, v25, v27
  v_mfma_f32_32x32x16_bf16 v[224:239], v[32:35], v[176:179], 0
  v_mfma_f32_32x32x16_bf16 v[240:255], v[48:51], v[176:179], 0
  v_mfma_f32_32x32x16_bf16 v[224:239], v[36:39], v[180:183], v[224:239]
  v_mfma_f32_32x32x16_bf16 v[240:255], v[52:55], v[180:183], v[240:255]
  v_mfma_f32_32x32x16_bf16 v[224:239], v[40:43], v[184:187], v[224:239]
  v_mfma_f32_32x32x16_bf16 v[240:255], v[56:59], v[184:187], v[240:255]
  v_mfma_f32_32x32x16_bf16 v[224:239], v[44:47], v[188:191], v[224:239]
  v_mfma_f32_32x32x16_bf16 v[240:255], v[60:63], v[188:191], v[240:255]
  s_setprio 0
  s_mov_b32 s54, 0xffff0000
  s_waitcnt vmcnt(7)
  v_lshlrev_b32 v12, 16, v128
  v_lshlrev_b32 v13, 16, v130
  v_lshlrev_b32 v16, 16, v129
  v_lshlrev_b32 v17, 16, v131
  v_and_b32 v14, s54, v128
  v_and_b32 v15, s54, v130
  v_and_b32 v18, s54, v129
  v_and_b32 v19, s54, v131
  v_pk_add_f32 v[20:21], v[12:13], v[16:17]
  v_pk_add_f32 v[22:23], v[14:15], v[18:19]
  v_pk_add_f32 v[12:13], v[12:13], v[16:17] neg_lo:[0,1] neg_hi:[0,1]
  v_pk_add_f32 v[14:15], v[14:15], v[18:19] neg_lo:[0,1] neg_hi:[0,1]
  v_pk_fma_f32 v[16:17], v[12:13], v[112:113], v[20:21] neg_lo:[1,0,0] neg_hi:[1,0,0]
  v_pk_fma_f32 v[18:19], v[14:15], v[112:113], v[22:23] neg_lo:[1,0,0] neg_hi:[1,0,0]
  v_pk_fma_f32 v[20:21], v[12:13], v[112:113], v[20:21]
  v_pk_fma_f32 v[22:23], v[14:15], v[112:113], v[22:23]
  v_pk_mul_f32 v[12:13], v[12:13], v[96:97]
  v_pk_mul_f32 v[14:15], v[14:15], v[96:97]
  v_pk_mul_f32 v[24:25], v[16:17], v[192:193]
  v_pk_mul_f32 v[26:27], v[16:17], v[208:209]
  v_pk_mul_f32 v[28:29], v[20:21], v[224:225]
  v_pk_mul_f32 v[30:31], v[20:21], v[240:241]
  v_pk_fma_f32 v[24:25], v[18:19], v[208:209], v[24:25] neg_lo:[1,0,0] neg_hi:[1,0,0]
  v_pk_fma_f32 v[26:27], v[18:19], v[192:193], v[26:27]
  v_pk_fma_f32 v[28:29], v[22:23], v[240:241], v[28:29] neg_lo:[1,0,0] neg_hi:[1,0,0]
  v_pk_fma_f32 v[30:31], v[22:23], v[224:225], v[30:31]
  v_pk_fma_f32 v[24:25], v[12:13], v[240:241], v[24:25] neg_lo:[1,0,0] neg_hi:[1,0,0]
  v_pk_fma_f32 v[26:27], v[12:13], v[224:225], v[26:27]
  v_pk_fma_f32 v[28:29], v[12:13], v[208:209], v[28:29]
  v_pk_fma_f32 v[30:31], v[12:13], v[192:193], v[30:31] neg_lo:[1,0,0] neg_hi:[1,0,0]
  v_pk_fma_f32 v[24:25], v[14:15], v[224:225], v[24:25] neg_lo:[1,0,0] neg_hi:[1,0,0]
  v_pk_fma_f32 v[26:27], v[14:15], v[240:241], v[26:27] neg_lo:[1,0,0] neg_hi:[1,0,0]
  v_pk_fma_f32 v[28:29], v[14:15], v[192:193], v[28:29]
  v_pk_fma_f32 v[30:31], v[14:15], v[208:209], v[30:31]
  v_cvt_pk_bf16_f32 v160, v26, v24
  v_cvt_pk_bf16_f32 v161, v27, v25
  v_cvt_pk_bf16_f32 v176, v30, v28
  v_cvt_pk_bf16_f32 v177, v31, v29
  s_waitcnt vmcnt(6)
  v_lshlrev_b32 v12, 16, v132
  v_lshlrev_b32 v13, 16, v134
  v_lshlrev_b32 v16, 16, v133
  v_lshlrev_b32 v17, 16, v135
  v_and_b32 v14, s54, v132
  v_and_b32 v15, s54, v134
  v_and_b32 v18, s54, v133
  v_and_b32_e64 v19, s54, v135
  v_pk_add_f32 v[20:21], v[12:13], v[16:17]
  v_pk_add_f32 v[22:23], v[14:15], v[18:19]
  v_pk_add_f32 v[12:13], v[12:13], v[16:17] neg_lo:[0,1] neg_hi:[0,1]
  v_pk_add_f32 v[14:15], v[14:15], v[18:19] neg_lo:[0,1] neg_hi:[0,1]
  v_pk_fma_f32 v[16:17], v[12:13], v[114:115], v[20:21] neg_lo:[1,0,0] neg_hi:[1,0,0]
  v_pk_fma_f32 v[18:19], v[14:15], v[114:115], v[22:23] neg_lo:[1,0,0] neg_hi:[1,0,0]
  v_pk_fma_f32 v[20:21], v[12:13], v[114:115], v[20:21]
  v_pk_fma_f32 v[22:23], v[14:15], v[114:115], v[22:23]
  v_pk_mul_f32 v[12:13], v[12:13], v[98:99]
  v_pk_mul_f32 v[14:15], v[14:15], v[98:99]
  v_pk_mul_f32 v[24:25], v[16:17], v[194:195]
  v_pk_mul_f32 v[26:27], v[16:17], v[210:211]
  v_pk_mul_f32 v[28:29], v[20:21], v[226:227]
  v_pk_mul_f32 v[30:31], v[20:21], v[242:243]
  v_pk_fma_f32 v[24:25], v[18:19], v[210:211], v[24:25] neg_lo:[1,0,0] neg_hi:[1,0,0]
  v_pk_fma_f32 v[26:27], v[18:19], v[194:195], v[26:27]
  v_pk_fma_f32 v[28:29], v[22:23], v[242:243], v[28:29] neg_lo:[1,0,0] neg_hi:[1,0,0]
  v_pk_fma_f32 v[30:31], v[22:23], v[226:227], v[30:31]
  v_pk_fma_f32 v[24:25], v[12:13], v[242:243], v[24:25] neg_lo:[1,0,0] neg_hi:[1,0,0]
  v_pk_fma_f32 v[26:27], v[12:13], v[226:227], v[26:27]
  v_pk_fma_f32 v[28:29], v[12:13], v[210:211], v[28:29]
  v_pk_fma_f32 v[30:31], v[12:13], v[194:195], v[30:31] neg_lo:[1,0,0] neg_hi:[1,0,0]
  v_pk_fma_f32 v[24:25], v[14:15], v[226:227], v[24:25] neg_lo:[1,0,0] neg_hi:[1,0,0]
  v_pk_fma_f32 v[26:27], v[14:15], v[242:243], v[26:27] neg_lo:[1,0,0] neg_hi:[1,0,0]
  v_pk_fma_f32 v[28:29], v[14:15], v[194:195], v[28:29]
  v_pk_fma_f32 v[30:31], v[14:15], v[210:211], v[30:31]
  v_cvt_pk_bf16_f32 v162, v26, v24
  v_cvt_pk_bf16_f32 v163, v27, v25
  v_cvt_pk_bf16_f32 v178, v30, v28
  v_cvt_pk_bf16_f32 v179, v31, v29
  s_waitcnt vmcnt(5)
  v_lshlrev_b32 v12, 16, v136
  v_lshlrev_b32 v13, 16, v138
  v_lshlrev_b32 v16, 16, v137
  v_lshlrev_b32 v17, 16, v139
  v_and_b32 v14, s54, v136
  v_and_b32 v15, s54, v138
  v_and_b32 v18, s54, v137
  v_and_b32_e64 v19, s54, v139
  v_pk_add_f32 v[20:21], v[12:13], v[16:17]
  v_pk_add_f32 v[22:23], v[14:15], v[18:19]
  v_pk_add_f32 v[12:13], v[12:13], v[16:17] neg_lo:[0,1] neg_hi:[0,1]
  v_pk_add_f32 v[14:15], v[14:15], v[18:19] neg_lo:[0,1] neg_hi:[0,1]
  v_pk_fma_f32 v[16:17], v[12:13], v[116:117], v[20:21] neg_lo:[1,0,0] neg_hi:[1,0,0]
  v_pk_fma_f32 v[18:19], v[14:15], v[116:117], v[22:23] neg_lo:[1,0,0] neg_hi:[1,0,0]
  v_pk_fma_f32 v[20:21], v[12:13], v[116:117], v[20:21]
  v_pk_fma_f32 v[22:23], v[14:15], v[116:117], v[22:23]
  v_pk_mul_f32 v[12:13], v[12:13], v[100:101]
  v_pk_mul_f32 v[14:15], v[14:15], v[100:101]
  v_pk_mul_f32 v[24:25], v[16:17], v[196:197]
  v_pk_mul_f32 v[26:27], v[16:17], v[212:213]
  v_pk_mul_f32 v[28:29], v[20:21], v[228:229]
  v_pk_mul_f32 v[30:31], v[20:21], v[244:245]
  v_pk_fma_f32 v[24:25], v[18:19], v[212:213], v[24:25] neg_lo:[1,0,0] neg_hi:[1,0,0]
  v_pk_fma_f32 v[26:27], v[18:19], v[196:197], v[26:27]
  v_pk_fma_f32 v[28:29], v[22:23], v[244:245], v[28:29] neg_lo:[1,0,0] neg_hi:[1,0,0]
  v_pk_fma_f32 v[30:31], v[22:23], v[228:229], v[30:31]
  v_pk_fma_f32 v[24:25], v[12:13], v[244:245], v[24:25] neg_lo:[1,0,0] neg_hi:[1,0,0]
  v_pk_fma_f32 v[26:27], v[12:13], v[228:229], v[26:27]
  v_pk_fma_f32 v[28:29], v[12:13], v[212:213], v[28:29]
  v_pk_fma_f32 v[30:31], v[12:13], v[196:197], v[30:31] neg_lo:[1,0,0] neg_hi:[1,0,0]
  v_pk_fma_f32 v[24:25], v[14:15], v[228:229], v[24:25] neg_lo:[1,0,0] neg_hi:[1,0,0]
  v_pk_fma_f32 v[26:27], v[14:15], v[244:245], v[26:27] neg_lo:[1,0,0] neg_hi:[1,0,0]
  v_pk_fma_f32 v[28:29], v[14:15], v[196:197], v[28:29]
  v_pk_fma_f32 v[30:31], v[14:15], v[212:213], v[30:31]
  v_cvt_pk_bf16_f32 v164, v26, v24
  v_cvt_pk_bf16_f32 v165, v27, v25
  v_cvt_pk_bf16_f32 v180, v30, v28
  v_cvt_pk_bf16_f32 v181, v31, v29
  s_waitcnt vmcnt(4)
  v_lshlrev_b32 v12, 16, v140
  v_lshlrev_b32 v13, 16, v142
  v_lshlrev_b32 v16, 16, v141
  v_lshlrev_b32 v17, 16, v143
  v_and_b32 v14, s54, v140
  v_and_b32 v15, s54, v142
  v_and_b32 v18, s54, v141
  v_and_b32_e64 v19, s54, v143
  v_pk_add_f32 v[20:21], v[12:13], v[16:17]
  v_pk_add_f32 v[22:23], v[14:15], v[18:19]
  v_pk_add_f32 v[12:13], v[12:13], v[16:17] neg_lo:[0,1] neg_hi:[0,1]
  v_pk_add_f32 v[14:15], v[14:15], v[18:19] neg_lo:[0,1] neg_hi:[0,1]
  v_pk_fma_f32 v[16:17], v[12:13], v[118:119], v[20:21] neg_lo:[1,0,0] neg_hi:[1,0,0]
  v_pk_fma_f32 v[18:19], v[14:15], v[118:119], v[22:23] neg_lo:[1,0,0] neg_hi:[1,0,0]
  v_pk_fma_f32 v[20:21], v[12:13], v[118:119], v[20:21]
  v_pk_fma_f32 v[22:23], v[14:15], v[118:119], v[22:23]
  v_pk_mul_f32 v[12:13], v[12:13], v[102:103]
  v_pk_mul_f32 v[14:15], v[14:15], v[102:103]
  v_pk_mul_f32 v[24:25], v[16:17], v[198:199]
  v_pk_mul_f32 v[26:27], v[16:17], v[214:215]
  v_pk_mul_f32 v[28:29], v[20:21], v[230:231]
  v_pk_mul_f32 v[30:31], v[20:21], v[246:247]
  v_pk_fma_f32 v[24:25], v[18:19], v[214:215], v[24:25] neg_lo:[1,0,0] neg_hi:[1,0,0]
  v_pk_fma_f32 v[26:27], v[18:19], v[198:199], v[26:27]
  v_pk_fma_f32 v[28:29], v[22:23], v[246:247], v[28:29] neg_lo:[1,0,0] neg_hi:[1,0,0]
  v_pk_fma_f32 v[30:31], v[22:23], v[230:231], v[30:31]
  v_pk_fma_f32 v[24:25], v[12:13], v[246:247], v[24:25] neg_lo:[1,0,0] neg_hi:[1,0,0]
  v_pk_fma_f32 v[26:27], v[12:13], v[230:231], v[26:27]
  v_pk_fma_f32 v[28:29], v[12:13], v[214:215], v[28:29]
  v_pk_fma_f32 v[30:31], v[12:13], v[198:199], v[30:31] neg_lo:[1,0,0] neg_hi:[1,0,0]
  v_pk_fma_f32 v[24:25], v[14:15], v[230:231], v[24:25] neg_lo:[1,0,0] neg_hi:[1,0,0]
  v_pk_fma_f32 v[26:27], v[14:15], v[246:247], v[26:27] neg_lo:[1,0,0] neg_hi:[1,0,0]
  v_pk_fma_f32 v[28:29], v[14:15], v[198:199], v[28:29]
  v_pk_fma_f32 v[30:31], v[14:15], v[214:215], v[30:31]
  v_cvt_pk_bf16_f32 v166, v26, v24
  v_cvt_pk_bf16_f32 v167, v27, v25
  v_cvt_pk_bf16_f32 v182, v30, v28
  v_cvt_pk_bf16_f32 v183, v31, v29
  s_waitcnt vmcnt(3)
  v_lshlrev_b32 v12, 16, v144
  v_lshlrev_b32 v13, 16, v146
  v_lshlrev_b32 v16, 16, v145
  v_lshlrev_b32 v17, 16, v147
  v_and_b32 v14, s54, v144
  v_and_b32 v15, s54, v146
  v_and_b32 v18, s54, v145
  v_and_b32_e64 v19, s54, v147
  v_pk_add_f32 v[20:21], v[12:13], v[16:17]
  v_pk_add_f32 v[22:23], v[14:15], v[18:19]
  v_pk_add_f32 v[12:13], v[12:13], v[16:17] neg_lo:[0,1] neg_hi:[0,1]
  v_pk_add_f32 v[14:15], v[14:15], v[18:19] neg_lo:[0,1] neg_hi:[0,1]
  v_pk_fma_f32 v[16:17], v[12:13], v[120:121], v[20:21] neg_lo:[1,0,0] neg_hi:[1,0,0]
  v_pk_fma_f32 v[18:19], v[14:15], v[120:121], v[22:23] neg_lo:[1,0,0] neg_hi:[1,0,0]
  v_pk_fma_f32 v[20:21], v[12:13], v[120:121], v[20:21]
  v_pk_fma_f32 v[22:23], v[14:15], v[120:121], v[22:23]
  v_pk_mul_f32 v[12:13], v[12:13], v[104:105]
  v_pk_mul_f32 v[14:15], v[14:15], v[104:105]
  v_pk_mul_f32 v[24:25], v[16:17], v[200:201]
  v_pk_mul_f32 v[26:27], v[16:17], v[216:217]
  v_pk_mul_f32 v[28:29], v[20:21], v[232:233]
  v_pk_mul_f32 v[30:31], v[20:21], v[248:249]
  v_pk_fma_f32 v[24:25], v[18:19], v[216:217], v[24:25] neg_lo:[1,0,0] neg_hi:[1,0,0]
  v_pk_fma_f32 v[26:27], v[18:19], v[200:201], v[26:27]
  v_pk_fma_f32 v[28:29], v[22:23], v[248:249], v[28:29] neg_lo:[1,0,0] neg_hi:[1,0,0]
  v_pk_fma_f32 v[30:31], v[22:23], v[232:233], v[30:31]
  v_pk_fma_f32 v[24:25], v[12:13], v[248:249], v[24:25] neg_lo:[1,0,0] neg_hi:[1,0,0]
  v_pk_fma_f32 v[26:27], v[12:13], v[232:233], v[26:27]
  v_pk_fma_f32 v[28:29], v[12:13], v[216:217], v[28:29]
  v_pk_fma_f32 v[30:31], v[12:13], v[200:201], v[30:31] neg_lo:[1,0,0] neg_hi:[1,0,0]
  v_pk_fma_f32 v[24:25], v[14:15], v[232:233], v[24:25] neg_lo:[1,0,0] neg_hi:[1,0,0]
  v_pk_fma_f32 v[26:27], v[14:15], v[248:249], v[26:27] neg_lo:[1,0,0] neg_hi:[1,0,0]
  v_pk_fma_f32 v[28:29], v[14:15], v[200:201], v[28:29]
  v_pk_fma_f32 v[30:31], v[14:15], v[216:217], v[30:31]
  v_cvt_pk_bf16_f32 v168, v26, v24
  v_cvt_pk_bf16_f32 v169, v27, v25
  v_cvt_pk_bf16_f32 v184, v30, v28
  v_cvt_pk_bf16_f32 v185, v31, v29
  s_waitcnt vmcnt(2)
  v_lshlrev_b32 v12, 16, v148
  v_lshlrev_b32 v13, 16, v150
  v_lshlrev_b32 v16, 16, v149
  v_lshlrev_b32 v17, 16, v151
  v_and_b32 v14, s54, v148
  v_and_b32 v15, s54, v150
  v_and_b32 v18, s54, v149
  v_and_b32_e64 v19, s54, v151
  v_pk_add_f32 v[20:21], v[12:13], v[16:17]
  v_pk_add_f32 v[22:23], v[14:15], v[18:19]
  v_pk_add_f32 v[12:13], v[12:13], v[16:17] neg_lo:[0,1] neg_hi:[0,1]
  v_pk_add_f32 v[14:15], v[14:15], v[18:19] neg_lo:[0,1] neg_hi:[0,1]
  v_pk_fma_f32 v[16:17], v[12:13], v[122:123], v[20:21] neg_lo:[1,0,0] neg_hi:[1,0,0]
  v_pk_fma_f32 v[18:19], v[14:15], v[122:123], v[22:23] neg_lo:[1,0,0] neg_hi:[1,0,0]
  v_pk_fma_f32 v[20:21], v[12:13], v[122:123], v[20:21]
  v_pk_fma_f32 v[22:23], v[14:15], v[122:123], v[22:23]
  v_pk_mul_f32 v[12:13], v[12:13], v[106:107]
  v_pk_mul_f32 v[14:15], v[14:15], v[106:107]
  v_pk_mul_f32 v[24:25], v[16:17], v[202:203]
  v_pk_mul_f32 v[26:27], v[16:17], v[218:219]
  v_pk_mul_f32 v[28:29], v[20:21], v[234:235]
  v_pk_mul_f32 v[30:31], v[20:21], v[250:251]
  v_pk_fma_f32 v[24:25], v[18:19], v[218:219], v[24:25] neg_lo:[1,0,0] neg_hi:[1,0,0]
  v_pk_fma_f32 v[26:27], v[18:19], v[202:203], v[26:27]
  v_pk_fma_f32 v[28:29], v[22:23], v[250:251], v[28:29] neg_lo:[1,0,0] neg_hi:[1,0,0]
  v_pk_fma_f32 v[30:31], v[22:23], v[234:235], v[30:31]
  v_pk_fma_f32 v[24:25], v[12:13], v[250:251], v[24:25] neg_lo:[1,0,0] neg_hi:[1,0,0]
  v_pk_fma_f32 v[26:27], v[12:13], v[234:235], v[26:27]
  v_pk_fma_f32 v[28:29], v[12:13], v[218:219], v[28:29]
  v_pk_fma_f32 v[30:31], v[12:13], v[202:203], v[30:31] neg_lo:[1,0,0] neg_hi:[1,0,0]
  v_pk_fma_f32 v[24:25], v[14:15], v[234:235], v[24:25] neg_lo:[1,0,0] neg_hi:[1,0,0]
  v_pk_fma_f32 v[26:27], v[14:15], v[250:251], v[26:27] neg_lo:[1,0,0] neg_hi:[1,0,0]
  v_pk_fma_f32 v[28:29], v[14:15], v[202:203], v[28:29]
  v_pk_fma_f32 v[30:31], v[14:15], v[218:219], v[30:31]
  v_cvt_pk_bf16_f32 v170, v26, v24
  v_cvt_pk_bf16_f32 v171, v27, v25
  v_cvt_pk_bf16_f32 v186, v30, v28
  v_cvt_pk_bf16_f32 v187, v31, v29
  s_waitcnt vmcnt(1)
  v_lshlrev_b32 v12, 16, v152
  v_lshlrev_b32 v13, 16, v154
  v_lshlrev_b32 v16, 16, v153
  v_lshlrev_b32 v17, 16, v155
  v_and_b32 v14, s54, v152
  v_and_b32 v15, s54, v154
  v_and_b32 v18, s54, v153
  v_and_b32_e64 v19, s54, v155
  v_pk_add_f32 v[20:21], v[12:13], v[16:17]
  v_pk_add_f32 v[22:23], v[14:15], v[18:19]
  v_pk_add_f32 v[12:13], v[12:13], v[16:17] neg_lo:[0,1] neg_hi:[0,1]
  v_pk_add_f32 v[14:15], v[14:15], v[18:19] neg_lo:[0,1] neg_hi:[0,1]
  v_pk_fma_f32 v[16:17], v[12:13], v[124:125], v[20:21] neg_lo:[1,0,0] neg_hi:[1,0,0]
  v_pk_fma_f32 v[18:19], v[14:15], v[124:125], v[22:23] neg_lo:[1,0,0] neg_hi:[1,0,0]
  v_pk_fma_f32 v[20:21], v[12:13], v[124:125], v[20:21]
  v_pk_fma_f32 v[22:23], v[14:15], v[124:125], v[22:23]
  v_pk_mul_f32 v[12:13], v[12:13], v[108:109]
  v_pk_mul_f32 v[14:15], v[14:15], v[108:109]
  v_pk_mul_f32 v[24:25], v[16:17], v[204:205]
  v_pk_mul_f32 v[26:27], v[16:17], v[220:221]
  v_pk_mul_f32 v[28:29], v[20:21], v[236:237]
  v_pk_mul_f32 v[30:31], v[20:21], v[252:253]
  v_pk_fma_f32 v[24:25], v[18:19], v[220:221], v[24:25] neg_lo:[1,0,0] neg_hi:[1,0,0]
  v_pk_fma_f32 v[26:27], v[18:19], v[204:205], v[26:27]
  v_pk_fma_f32 v[28:29], v[22:23], v[252:253], v[28:29] neg_lo:[1,0,0] neg_hi:[1,0,0]
  v_pk_fma_f32 v[30:31], v[22:23], v[236:237], v[30:31]
  v_pk_fma_f32 v[24:25], v[12:13], v[252:253], v[24:25] neg_lo:[1,0,0] neg_hi:[1,0,0]
  v_pk_fma_f32 v[26:27], v[12:13], v[236:237], v[26:27]
  v_pk_fma_f32 v[28:29], v[12:13], v[220:221], v[28:29]
  v_pk_fma_f32 v[30:31], v[12:13], v[204:205], v[30:31] neg_lo:[1,0,0] neg_hi:[1,0,0]
  v_pk_fma_f32 v[24:25], v[14:15], v[236:237], v[24:25] neg_lo:[1,0,0] neg_hi:[1,0,0]
  v_pk_fma_f32 v[26:27], v[14:15], v[252:253], v[26:27] neg_lo:[1,0,0] neg_hi:[1,0,0]
  v_pk_fma_f32 v[28:29], v[14:15], v[204:205], v[28:29]
  v_pk_fma_f32 v[30:31], v[14:15], v[220:221], v[30:31]
  v_cvt_pk_bf16_f32 v172, v26, v24
  v_cvt_pk_bf16_f32 v173, v27, v25
  v_cvt_pk_bf16_f32 v188, v30, v28
  v_cvt_pk_bf16_f32 v189, v31, v29
  s_waitcnt vmcnt(0)
  v_lshlrev_b32 v12, 16, v156
  v_lshlrev_b32 v13, 16, v158
  v_lshlrev_b32 v16, 16, v157
  v_lshlrev_b32 v17, 16, v159
  v_and_b32 v14, s54, v156
  v_and_b32 v15, s54, v158
  v_and_b32 v18, s54, v157
  v_and_b32_e64 v19, s54, v159
  v_pk_add_f32 v[20:21], v[12:13], v[16:17]
  v_pk_add_f32 v[22:23], v[14:15], v[18:19]
  v_pk_add_f32 v[12:13], v[12:13], v[16:17] neg_lo:[0,1] neg_hi:[0,1]
  v_pk_add_f32 v[14:15], v[14:15], v[18:19] neg_lo:[0,1] neg_hi:[0,1]
  v_pk_fma_f32 v[16:17], v[12:13], v[126:127], v[20:21] neg_lo:[1,0,0] neg_hi:[1,0,0]
  v_pk_fma_f32 v[18:19], v[14:15], v[126:127], v[22:23] neg_lo:[1,0,0] neg_hi:[1,0,0]
  v_pk_fma_f32 v[20:21], v[12:13], v[126:127], v[20:21]
  v_pk_fma_f32 v[22:23], v[14:15], v[126:127], v[22:23]
  v_pk_mul_f32 v[12:13], v[12:13], v[110:111]
  v_pk_mul_f32 v[14:15], v[14:15], v[110:111]
  v_pk_mul_f32 v[24:25], v[16:17], v[206:207]
  v_pk_mul_f32 v[26:27], v[16:17], v[222:223]
  v_pk_mul_f32 v[28:29], v[20:21], v[238:239]
  v_pk_mul_f32 v[30:31], v[20:21], v[254:255]
  v_pk_fma_f32 v[24:25], v[18:19], v[222:223], v[24:25] neg_lo:[1,0,0] neg_hi:[1,0,0]
  v_pk_fma_f32 v[26:27], v[18:19], v[206:207], v[26:27]
  v_pk_fma_f32 v[28:29], v[22:23], v[254:255], v[28:29] neg_lo:[1,0,0] neg_hi:[1,0,0]
  v_pk_fma_f32 v[30:31], v[22:23], v[238:239], v[30:31]
  v_pk_fma_f32 v[24:25], v[12:13], v[254:255], v[24:25] neg_lo:[1,0,0] neg_hi:[1,0,0]
  v_pk_fma_f32 v[26:27], v[12:13], v[238:239], v[26:27]
  v_pk_fma_f32 v[28:29], v[12:13], v[222:223], v[28:29]
  v_pk_fma_f32 v[30:31], v[12:13], v[206:207], v[30:31] neg_lo:[1,0,0] neg_hi:[1,0,0]
  v_pk_fma_f32 v[24:25], v[14:15], v[238:239], v[24:25] neg_lo:[1,0,0] neg_hi:[1,0,0]
  v_pk_fma_f32 v[26:27], v[14:15], v[254:255], v[26:27] neg_lo:[1,0,0] neg_hi:[1,0,0]
  v_pk_fma_f32 v[28:29], v[14:15], v[206:207], v[28:29]
  v_pk_fma_f32 v[30:31], v[14:15], v[222:223], v[30:31]
  v_cvt_pk_bf16_f32 v174, v26, v24
  v_cvt_pk_bf16_f32 v175, v27, v25
  v_cvt_pk_bf16_f32 v190, v30, v28
  v_cvt_pk_bf16_f32 v191, v31, v29
	s_nop 0
  s_setprio 1
  v_mfma_f32_32x32x16_bf16 v[192:207], v[160:163], v[32:35], 0
  v_mfma_f32_32x32x16_bf16 v[208:223], v[160:163], v[48:51], 0
  v_mfma_f32_32x32x16_bf16 v[192:207], v[164:167], v[36:39], v[192:207]
  v_mfma_f32_32x32x16_bf16 v[208:223], v[164:167], v[52:55], v[208:223]
  v_mfma_f32_32x32x16_bf16 v[192:207], v[168:171], v[40:43], v[192:207]
  v_mfma_f32_32x32x16_bf16 v[208:223], v[168:171], v[56:59], v[208:223]
  v_mfma_f32_32x32x16_bf16 v[192:207], v[172:175], v[44:47], v[192:207]
  v_mfma_f32_32x32x16_bf16 v[208:223], v[172:175], v[60:63], v[208:223]
  v_mfma_f32_32x32x16_bf16 v[224:239], v[176:179], v[32:35], 0
  v_mfma_f32_32x32x16_bf16 v[240:255], v[176:179], v[48:51], 0
  v_mfma_f32_32x32x16_bf16 v[224:239], v[180:183], v[36:39], v[224:239]
	s_nop 0
  s_nop 7
  v_pk_mul_f32 v[20:21], v[192:193], v[64:65]
  v_pk_mul_f32 v[22:23], v[208:209], v[64:65]
  v_pk_fma_f32 v[20:21], v[208:209], v[80:81], v[20:21]
  v_pk_fma_f32 v[22:23], v[192:193], v[80:81], v[22:23] neg_lo:[1,0,0] neg_hi:[1,0,0]
  v_cvt_pk_bf16_f32 v160, v20, v22
  v_cvt_pk_bf16_f32 v161, v21, v23
  v_pk_mul_f32 v[24:25], v[194:195], v[66:67]
  v_pk_mul_f32 v[26:27], v[210:211], v[66:67]
  v_mfma_f32_32x32x16_bf16 v[240:255], v[180:183], v[52:55], v[240:255]
  v_pk_fma_f32 v[24:25], v[210:211], v[82:83], v[24:25]
  v_pk_fma_f32 v[26:27], v[194:195], v[82:83], v[26:27] neg_lo:[1,0,0] neg_hi:[1,0,0]
  v_cvt_pk_bf16_f32 v162, v24, v26
  v_cvt_pk_bf16_f32 v163, v25, v27
  v_pk_mul_f32 v[20:21], v[196:197], v[68:69]
  v_pk_mul_f32 v[22:23], v[212:213], v[68:69]
  v_pk_fma_f32 v[20:21], v[212:213], v[84:85], v[20:21]
  v_pk_fma_f32 v[22:23], v[196:197], v[84:85], v[22:23] neg_lo:[1,0,0] neg_hi:[1,0,0]
  v_mfma_f32_32x32x16_bf16 v[224:239], v[184:187], v[40:43], v[224:239]
  v_cvt_pk_bf16_f32 v164, v20, v22
  v_cvt_pk_bf16_f32 v165, v21, v23
  v_pk_mul_f32 v[24:25], v[198:199], v[70:71]
  v_pk_mul_f32 v[26:27], v[214:215], v[70:71]
  v_pk_fma_f32 v[24:25], v[214:215], v[86:87], v[24:25]
  v_pk_fma_f32 v[26:27], v[198:199], v[86:87], v[26:27] neg_lo:[1,0,0] neg_hi:[1,0,0]
  v_cvt_pk_bf16_f32 v166, v24, v26
  v_cvt_pk_bf16_f32 v167, v25, v27
  v_mfma_f32_32x32x16_bf16 v[240:255], v[184:187], v[56:59], v[240:255]
  v_pk_mul_f32 v[20:21], v[200:201], v[72:73]
  v_pk_mul_f32 v[22:23], v[216:217], v[72:73]
  v_pk_fma_f32 v[20:21], v[216:217], v[88:89], v[20:21]
  v_pk_fma_f32 v[22:23], v[200:201], v[88:89], v[22:23] neg_lo:[1,0,0] neg_hi:[1,0,0]
  v_cvt_pk_bf16_f32 v168, v20, v22
  v_cvt_pk_bf16_f32 v169, v21, v23
  v_pk_mul_f32 v[24:25], v[202:203], v[74:75]
  v_pk_mul_f32 v[26:27], v[218:219], v[74:75]
  v_mfma_f32_32x32x16_bf16 v[224:239], v[188:191], v[44:47], v[224:239]
  v_pk_fma_f32 v[24:25], v[218:219], v[90:91], v[24:25]
  v_pk_fma_f32 v[26:27], v[202:203], v[90:91], v[26:27] neg_lo:[1,0,0] neg_hi:[1,0,0]
  v_cvt_pk_bf16_f32 v170, v24, v26
  v_cvt_pk_bf16_f32 v171, v25, v27
  v_pk_mul_f32 v[20:21], v[204:205], v[76:77]
  v_pk_mul_f32 v[22:23], v[220:221], v[76:77]
  v_pk_fma_f32 v[20:21], v[220:221], v[92:93], v[20:21]
  v_pk_fma_f32 v[22:23], v[204:205], v[92:93], v[22:23] neg_lo:[1,0,0] neg_hi:[1,0,0]
  v_mfma_f32_32x32x16_bf16 v[240:255], v[188:191], v[60:63], v[240:255]
  v_cvt_pk_bf16_f32 v172, v20, v22
  v_cvt_pk_bf16_f32 v173, v21, v23
  v_pk_mul_f32 v[24:25], v[206:207], v[78:79]
  v_pk_mul_f32 v[26:27], v[222:223], v[78:79]
  v_pk_fma_f32 v[24:25], v[222:223], v[94:95], v[24:25]
  v_pk_fma_f32 v[26:27], v[206:207], v[94:95], v[26:27] neg_lo:[1,0,0] neg_hi:[1,0,0]
  v_cvt_pk_bf16_f32 v174, v24, v26
  v_cvt_pk_bf16_f32 v175, v25, v27
  v_mfma_f32_32x32x16_bf16 v[192:207], v[32:35], v[160:163], 0
  v_mfma_f32_32x32x16_bf16 v[208:223], v[48:51], v[160:163], 0
  v_pk_mul_f32 v[20:21], v[224:225], v[64:65]
	s_nop 0
  s_nop 0
  v_pk_mul_f32 v[22:23], v[240:241], v[64:65]
  v_pk_fma_f32 v[20:21], v[240:241], v[80:81], v[20:21]
  v_pk_fma_f32 v[22:23], v[224:225], v[80:81], v[22:23] neg_lo:[1,0,0] neg_hi:[1,0,0]
  v_cvt_pk_bf16_f32 v176, v20, v22
  v_cvt_pk_bf16_f32 v177, v21, v23
  v_pk_mul_f32 v[24:25], v[226:227], v[66:67]
  v_mfma_f32_32x32x16_bf16 v[192:207], v[36:39], v[164:167], v[192:207]
  v_pk_mul_f32 v[26:27], v[242:243], v[66:67]
  v_pk_fma_f32 v[24:25], v[242:243], v[82:83], v[24:25]
  v_pk_fma_f32 v[26:27], v[226:227], v[82:83], v[26:27] neg_lo:[1,0,0] neg_hi:[1,0,0]
  v_cvt_pk_bf16_f32 v178, v24, v26
  v_cvt_pk_bf16_f32 v179, v25, v27
  v_pk_mul_f32 v[20:21], v[228:229], v[68:69]
  v_pk_mul_f32 v[22:23], v[244:245], v[68:69]
  v_mfma_f32_32x32x16_bf16 v[208:223], v[52:55], v[164:167], v[208:223]
  v_pk_fma_f32 v[20:21], v[244:245], v[84:85], v[20:21]
  v_pk_fma_f32 v[22:23], v[228:229], v[84:85], v[22:23] neg_lo:[1,0,0] neg_hi:[1,0,0]
  v_cvt_pk_bf16_f32 v180, v20, v22
  v_cvt_pk_bf16_f32 v181, v21, v23
  v_pk_mul_f32 v[24:25], v[230:231], v[70:71]
  v_pk_mul_f32 v[26:27], v[246:247], v[70:71]
  v_pk_fma_f32 v[24:25], v[246:247], v[86:87], v[24:25]
  v_mfma_f32_32x32x16_bf16 v[192:207], v[40:43], v[168:171], v[192:207]
  v_pk_fma_f32 v[26:27], v[230:231], v[86:87], v[26:27] neg_lo:[1,0,0] neg_hi:[1,0,0]
  v_cvt_pk_bf16_f32 v182, v24, v26
  v_cvt_pk_bf16_f32 v183, v25, v27
  v_pk_mul_f32 v[20:21], v[232:233], v[72:73]
  v_pk_mul_f32 v[22:23], v[248:249], v[72:73]
  v_pk_fma_f32 v[20:21], v[248:249], v[88:89], v[20:21]
  v_pk_fma_f32 v[22:23], v[232:233], v[88:89], v[22:23] neg_lo:[1,0,0] neg_hi:[1,0,0]
  v_mfma_f32_32x32x16_bf16 v[208:223], v[56:59], v[168:171], v[208:223]
  v_cvt_pk_bf16_f32 v184, v20, v22
  v_cvt_pk_bf16_f32 v185, v21, v23
  v_pk_mul_f32 v[24:25], v[234:235], v[74:75]
  v_pk_mul_f32 v[26:27], v[250:251], v[74:75]
  v_pk_fma_f32 v[24:25], v[250:251], v[90:91], v[24:25]
  v_pk_fma_f32 v[26:27], v[234:235], v[90:91], v[26:27] neg_lo:[1,0,0] neg_hi:[1,0,0]
  v_cvt_pk_bf16_f32 v186, v24, v26
  v_mfma_f32_32x32x16_bf16 v[192:207], v[44:47], v[172:175], v[192:207]
  v_cvt_pk_bf16_f32 v187, v25, v27
  v_pk_mul_f32 v[20:21], v[236:237], v[76:77]
  v_pk_mul_f32 v[22:23], v[252:253], v[76:77]
  v_pk_fma_f32 v[20:21], v[252:253], v[92:93], v[20:21]
  v_pk_fma_f32 v[22:23], v[236:237], v[92:93], v[22:23] neg_lo:[1,0,0] neg_hi:[1,0,0]
  v_cvt_pk_bf16_f32 v188, v20, v22
  v_cvt_pk_bf16_f32 v189, v21, v23
  v_mfma_f32_32x32x16_bf16 v[208:223], v[60:63], v[172:175], v[208:223]
  v_pk_mul_f32 v[24:25], v[238:239], v[78:79]
  v_pk_mul_f32 v[26:27], v[254:255], v[78:79]
  v_pk_fma_f32 v[24:25], v[254:255], v[94:95], v[24:25]
  v_pk_fma_f32 v[26:27], v[238:239], v[94:95], v[26:27] neg_lo:[1,0,0] neg_hi:[1,0,0]
  v_cvt_pk_bf16_f32 v190, v24, v26
  v_cvt_pk_bf16_f32 v191, v25, v27
  v_mfma_f32_32x32x16_bf16 v[224:239], v[32:35], v[176:179], 0
  v_mfma_f32_32x32x16_bf16 v[240:255], v[48:51], v[176:179], 0
  v_mfma_f32_32x32x16_bf16 v[224:239], v[36:39], v[180:183], v[224:239]
  v_mfma_f32_32x32x16_bf16 v[240:255], v[52:55], v[180:183], v[240:255]
  v_mfma_f32_32x32x16_bf16 v[224:239], v[40:43], v[184:187], v[224:239]
  v_mfma_f32_32x32x16_bf16 v[240:255], v[56:59], v[184:187], v[240:255]
  v_mfma_f32_32x32x16_bf16 v[224:239], v[44:47], v[188:191], v[224:239]
  v_mfma_f32_32x32x16_bf16 v[240:255], v[60:63], v[188:191], v[240:255]
	s_nop 0
  s_setprio 1
  s_and_b32 s55, s48, 511
  s_cmp_eq_u32 s55, 0
  s_nop 7
  s_nop 7
  s_cbranch_scc0 noself_1012
  v_pk_add_f32 v[192:193], v[192:193], v[224:225] neg_lo:[0,1] neg_hi:[0,1]
  v_pk_add_f32 v[208:209], v[208:209], v[240:241]
  v_pk_mul_f32 v[192:193], v[192:193], 0.5 op_sel_hi:[1,0]
  v_pk_mul_f32 v[208:209], v[208:209], 0.5 op_sel_hi:[1,0]
  v_pk_add_f32 v[224:225], v[192:193], 0 op_sel_hi:[1,0] neg_lo:[1,0] neg_hi:[1,0]
  v_pk_add_f32 v[240:241], v[208:209], 0 op_sel_hi:[1,0]
  v_pk_add_f32 v[194:195], v[194:195], v[226:227] neg_lo:[0,1] neg_hi:[0,1]
  v_pk_add_f32 v[210:211], v[210:211], v[242:243]
  v_pk_mul_f32 v[194:195], v[194:195], 0.5 op_sel_hi:[1,0]
  v_pk_mul_f32 v[210:211], v[210:211], 0.5 op_sel_hi:[1,0]
  v_pk_add_f32 v[226:227], v[194:195], 0 op_sel_hi:[1,0] neg_lo:[1,0] neg_hi:[1,0]
  v_pk_add_f32 v[242:243], v[210:211], 0 op_sel_hi:[1,0]
  v_pk_add_f32 v[196:197], v[196:197], v[228:229] neg_lo:[0,1] neg_hi:[0,1]
  v_pk_add_f32 v[212:213], v[212:213], v[244:245]
  v_pk_mul_f32 v[196:197], v[196:197], 0.5 op_sel_hi:[1,0]
  v_pk_mul_f32 v[212:213], v[212:213], 0.5 op_sel_hi:[1,0]
  v_pk_add_f32 v[228:229], v[196:197], 0 op_sel_hi:[1,0] neg_lo:[1,0] neg_hi:[1,0]
  v_pk_add_f32 v[244:245], v[212:213], 0 op_sel_hi:[1,0]
  v_pk_add_f32 v[198:199], v[198:199], v[230:231] neg_lo:[0,1] neg_hi:[0,1]
  v_pk_add_f32 v[214:215], v[214:215], v[246:247]
  v_pk_mul_f32 v[198:199], v[198:199], 0.5 op_sel_hi:[1,0]
  v_pk_mul_f32 v[214:215], v[214:215], 0.5 op_sel_hi:[1,0]
  v_pk_add_f32 v[230:231], v[198:199], 0 op_sel_hi:[1,0] neg_lo:[1,0] neg_hi:[1,0]
  v_pk_add_f32 v[246:247], v[214:215], 0 op_sel_hi:[1,0]
  v_pk_add_f32 v[200:201], v[200:201], v[232:233] neg_lo:[0,1] neg_hi:[0,1]
  v_pk_add_f32 v[216:217], v[216:217], v[248:249]
  v_pk_mul_f32 v[200:201], v[200:201], 0.5 op_sel_hi:[1,0]
  v_pk_mul_f32 v[216:217], v[216:217], 0.5 op_sel_hi:[1,0]
  v_pk_add_f32 v[232:233], v[200:201], 0 op_sel_hi:[1,0] neg_lo:[1,0] neg_hi:[1,0]
  v_pk_add_f32 v[248:249], v[216:217], 0 op_sel_hi:[1,0]
  v_pk_add_f32 v[202:203], v[202:203], v[234:235] neg_lo:[0,1] neg_hi:[0,1]
  v_pk_add_f32 v[218:219], v[218:219], v[250:251]
  v_pk_mul_f32 v[202:203], v[202:203], 0.5 op_sel_hi:[1,0]
  v_pk_mul_f32 v[218:219], v[218:219], 0.5 op_sel_hi:[1,0]
  v_pk_add_f32 v[234:235], v[202:203], 0 op_sel_hi:[1,0] neg_lo:[1,0] neg_hi:[1,0]
  v_pk_add_f32 v[250:251], v[218:219], 0 op_sel_hi:[1,0]
  v_pk_add_f32 v[204:205], v[204:205], v[236:237] neg_lo:[0,1] neg_hi:[0,1]
  v_pk_add_f32 v[220:221], v[220:221], v[252:253]
  v_pk_mul_f32 v[204:205], v[204:205], 0.5 op_sel_hi:[1,0]
  v_pk_mul_f32 v[220:221], v[220:221], 0.5 op_sel_hi:[1,0]
  v_pk_add_f32 v[236:237], v[204:205], 0 op_sel_hi:[1,0] neg_lo:[1,0] neg_hi:[1,0]
  v_pk_add_f32 v[252:253], v[220:221], 0 op_sel_hi:[1,0]
  v_pk_add_f32 v[206:207], v[206:207], v[238:239] neg_lo:[0,1] neg_hi:[0,1]
  v_pk_add_f32 v[222:223], v[222:223], v[254:255]
  v_pk_mul_f32 v[206:207], v[206:207], 0.5 op_sel_hi:[1,0]
  v_pk_mul_f32 v[222:223], v[222:223], 0.5 op_sel_hi:[1,0]
  v_pk_add_f32 v[238:239], v[206:207], 0 op_sel_hi:[1,0] neg_lo:[1,0] neg_hi:[1,0]
  v_pk_add_f32 v[254:255], v[222:223], 0 op_sel_hi:[1,0]
noself_1012:
  v_cvt_pk_bf16_f32 v160, v192, v208
  v_cvt_pk_bf16_f32 v176, -v224, v240
  ds_write_b32 v7, v160 offset:0
  ds_write_b32 v8, v176 offset:0
  v_cvt_pk_bf16_f32 v161, v193, v209
  v_cvt_pk_bf16_f32 v177, -v225, v241
  ds_write_b32 v7, v161 offset:32
  ds_write_b32 v8, v177 offset:32
  v_cvt_pk_bf16_f32 v162, v194, v210
  v_cvt_pk_bf16_f32 v178, -v226, v242
  ds_write_b32 v7, v162 offset:64
  ds_write_b32 v8, v178 offset:64
  v_cvt_pk_bf16_f32 v163, v195, v211
  v_cvt_pk_bf16_f32 v179, -v227, v243
  ds_write_b32 v7, v163 offset:96
  ds_write_b32 v8, v179 offset:96
  v_cvt_pk_bf16_f32 v164, v196, v212
  v_cvt_pk_bf16_f32 v180, -v228, v244
  ds_write_b32 v7, v164 offset:9216
  ds_write_b32 v8, v180 offset:9216
  v_cvt_pk_bf16_f32 v165, v197, v213
  v_cvt_pk_bf16_f32 v181, -v229, v245
  ds_write_b32 v7, v165 offset:9248
  ds_write_b32 v8, v181 offset:9248
  v_cvt_pk_bf16_f32 v166, v198, v214
  v_cvt_pk_bf16_f32 v182, -v230, v246
  ds_write_b32 v7, v166 offset:9280
  ds_write_b32 v8, v182 offset:9280
  v_cvt_pk_bf16_f32 v167, v199, v215
  v_cvt_pk_bf16_f32 v183, -v231, v247
  ds_write_b32 v7, v167 offset:9312
  ds_write_b32 v8, v183 offset:9312
  v_cvt_pk_bf16_f32 v168, v200, v216
  v_cvt_pk_bf16_f32 v184, -v232, v248
  ds_write_b32 v7, v168 offset:18432
  ds_write_b32 v8, v184 offset:18432
  v_cvt_pk_bf16_f32 v169, v201, v217
  v_cvt_pk_bf16_f32 v185, -v233, v249
  ds_write_b32 v7, v169 offset:18464
  ds_write_b32 v8, v185 offset:18464
  v_cvt_pk_bf16_f32 v170, v202, v218
  v_cvt_pk_bf16_f32 v186, -v234, v250
  ds_write_b32 v7, v170 offset:18496
  ds_write_b32 v8, v186 offset:18496
  v_cvt_pk_bf16_f32 v171, v203, v219
  v_cvt_pk_bf16_f32 v187, -v235, v251
  ds_write_b32 v7, v171 offset:18528
  ds_write_b32 v8, v187 offset:18528
  v_cvt_pk_bf16_f32 v172, v204, v220
  v_cvt_pk_bf16_f32 v188, -v236, v252
  ds_write_b32 v7, v172 offset:27648
  ds_write_b32 v8, v188 offset:27648
  v_cvt_pk_bf16_f32 v173, v205, v221
  v_cvt_pk_bf16_f32 v189, -v237, v253
  ds_write_b32 v7, v173 offset:27680
  ds_write_b32 v8, v189 offset:27680
  v_cvt_pk_bf16_f32 v174, v206, v222
  v_cvt_pk_bf16_f32 v190, -v238, v254
  ds_write_b32 v7, v174 offset:27712
  ds_write_b32 v8, v190 offset:27712
  v_cvt_pk_bf16_f32 v175, v207, v223
  v_cvt_pk_bf16_f32 v191, -v239, v255
  ds_write_b32 v7, v175 offset:27744
  ds_write_b32 v8, v191 offset:27744
  s_waitcnt lgkmcnt(0)
  s_barrier
  ds_read_b128 v[192:195], v9 offset:0
  ds_read_b128 v[196:199], v9 offset:4608
  ds_read_b128 v[200:203], v9 offset:9216
  ds_read_b128 v[204:207], v9 offset:13824
  ds_read_b128 v[208:211], v9 offset:18432
  ds_read_b128 v[212:215], v9 offset:23040
  ds_read_b128 v[216:219], v9 offset:27648
  ds_read_b128 v[220:223], v9 offset:32256
  s_waitcnt lgkmcnt(7)
  buffer_store_dwordx4 v[192:195], v10, s[32:35], s53 offen sc1
  s_add_u32 s53, s53, 528384
  s_waitcnt lgkmcnt(6)
  buffer_store_dwordx4 v[196:199], v10, s[32:35], s53 offen sc1
  s_add_u32 s53, s53, 528384
  s_waitcnt lgkmcnt(5)
  buffer_store_dwordx4 v[200:203], v10, s[32:35], s53 offen sc1
  s_add_u32 s53, s53, 528384
  s_waitcnt lgkmcnt(4)
  buffer_store_dwordx4 v[204:207], v10, s[32:35], s53 offen sc1
  s_add_u32 s53, s53, 528384
  s_waitcnt lgkmcnt(3)
  buffer_store_dwordx4 v[208:211], v10, s[32:35], s53 offen sc1
  s_add_u32 s53, s53, 528384
  s_waitcnt lgkmcnt(2)
  buffer_store_dwordx4 v[212:215], v10, s[32:35], s53 offen sc1
  s_add_u32 s53, s53, 528384
  s_waitcnt lgkmcnt(1)
  buffer_store_dwordx4 v[216:219], v10, s[32:35], s53 offen sc1
  s_add_u32 s53, s53, 528384
  s_waitcnt lgkmcnt(0)
  buffer_store_dwordx4 v[220:223], v10, s[32:35], s53 offen sc1
  v_mov_b32_e64 v17, 0
  v_mov_b32 v18, 1
  s_lshl_b32 s69, s2, 4
  s_add_u32 s69, s69, 12288
  s_waitcnt vmcnt(0)
  s_barrier
  s_cmp_eq_u32 s40, 0
  s_cbranch_scc0 w0_1013
  s_mov_b64 exec, 1
  v_mov_b32 v19, 1
  s_mov_b32 s69, 12288
  buffer_atomic_add v19, v17, s[60:63], s69 offen sc0
  s_waitcnt vmcnt(0)
  v_cmp_eq_u32 vcc, 128, v19
  s_cbranch_vccz nogo_1014
  buffer_store_dword v18, v17, s[60:63], s69 offen offset:256 sc1
nogo_1014:
  s_mov_b64 exec, -1
w0_1013:
  s_setprio 0
b3_1007:
  s_add_u32 s24, s20, 11534336
	s_nop 0
  s_addc_u32 s25, s21, 0
  s_mov_b32 s26, 4227072
  s_mov_b32 s27, 0x00020000
  s_mov_b32 s32, s16
  s_mov_b32 s33, s17
  s_mov_b32 s34, 8388608
  s_mov_b32 s35, 0x00020000
  s_mov_b32 s46, 0x35000000
  v_pk_mul_f32 v[64:65], v[64:65], s[46:47] op_sel_hi:[1,0]
  v_pk_mul_f32 v[80:81], v[80:81], s[46:47] op_sel_hi:[1,0]
  v_pk_mul_f32 v[66:67], v[66:67], s[46:47] op_sel_hi:[1,0]
  v_pk_mul_f32 v[82:83], v[82:83], s[46:47] op_sel_hi:[1,0]
  v_pk_mul_f32 v[68:69], v[68:69], s[46:47] op_sel_hi:[1,0]
  v_pk_mul_f32 v[84:85], v[84:85], s[46:47] op_sel_hi:[1,0]
  v_pk_mul_f32 v[70:71], v[70:71], s[46:47] op_sel_hi:[1,0]
  v_pk_mul_f32 v[86:87], v[86:87], s[46:47] op_sel_hi:[1,0]
  v_pk_mul_f32 v[72:73], v[72:73], s[46:47] op_sel_hi:[1,0]
  v_pk_mul_f32 v[88:89], v[88:89], s[46:47] op_sel_hi:[1,0]
  v_pk_mul_f32 v[74:75], v[74:75], s[46:47] op_sel_hi:[1,0]
  v_pk_mul_f32 v[90:91], v[90:91], s[46:47] op_sel_hi:[1,0]
  v_pk_mul_f32 v[76:77], v[76:77], s[46:47] op_sel_hi:[1,0]
  v_pk_mul_f32 v[92:93], v[92:93], s[46:47] op_sel_hi:[1,0]
  v_pk_mul_f32 v[78:79], v[78:79], s[46:47] op_sel_hi:[1,0]
  v_pk_mul_f32 v[94:95], v[94:95], s[46:47] op_sel_hi:[1,0]
  v_lshrrev_b32 v20, 3, v1
  v_lshlrev_b32 v20, 7, v20
  v_lshrrev_b32 v21, 4, v1
  v_and_b32 v22, 7, v1
  v_xor_b32 v21, v21, v22
  v_lshlrev_b32 v21, 4, v21
  v_add_u32 v2, v20, v21
  v_xor_b32 v3, 64, v2
  s_mul_i32 s41, s2, 16512
  s_lshl_b32 s42, s40, 12
  s_add_u32 s43, s41, s42
  v_lshlrev_b32 v9, 4, v1
  v_add_u32 v10, s42, v9
  v_lshrrev_b32_e64 v20, 5, v1
  v_lshlrev_b32 v20, 12, v20
  s_lshl_b32 s44, s40, 5
  s_add_u32 s44, s44, 16400
  v_sub_u32_e64 v4, s44, v20
  v_add_u32 v5, 4294959104, v4
  v_lshlrev_b32 v20, 7, v1
  s_lshl_b32 s45, s40, 1
  v_bfe_u32 v21, v1, 1, 3
  v_xor_b32 v21, s45, v21
  v_lshlrev_b32 v21, 4, v21
  v_add_u32 v6, v20, v21
  v_sub_u32 v20, 32, v1
  v_and_b32 v20, 31, v20
  v_lshrrev_b32 v22, 5, v1
  v_xor_b32 v22, 1, v22
  v_lshlrev_b32 v22, 5, v22
  v_add_u32_e64 v22, v22, v20
  v_lshlrev_b32 v22, 7, v22
  s_or_b32 s45, s45, 1
  v_bfe_u32 v21, v20, 1, 3
  v_xor_b32 v21, s45, v21
  v_lshlrev_b32 v21, 4, v21
  v_add_u32 v7, v22, v21
  s_lshr_b32 s46, s2, 5
  s_lshl_b32 s46, s46, 2
  s_add_u32 s46, s46, s40
  s_lshl_b32 s46, s46, 5
  s_and_b32 s47, s2, 31
  s_add_u32 s46, s46, s47
  s_lshl_b32 s46, s46, 13
  s_add_u32 s46, s46, 2048
  s_add_u32 s47, s46, 4096
  v_and_b32 v20, 31, v1
  v_lshlrev_b32 v20, 6, v20
  v_lshrrev_b32 v21, 5, v1
  v_lshlrev_b32 v21, 4, v21
  v_add_u32 v8, v20, v21
  v_and_b32 v20, 31, v1
  v_cmp_eq_u32 s[48:49], 0, v20
  v_mov_b32_e64 v17, 0
  s_mov_b32 s58, 12288
  s_cmp_eq_u32 s40, 0
  s_cbranch_scc0 w0_1015
  s_mov_b32 s59, 40000
spin_1017:
  buffer_load_dword v20, v17, s[60:63], s58 offen offset:256 sc1
  s_waitcnt vmcnt(0)
  v_cmp_ne_u32 vcc, 1, v20
  s_cbranch_vccz ok_1016
  s_sleep 8
  s_sub_u32 s59, s59, 1
  s_cmp_lg_u32 s59, 0
  s_cbranch_scc1 spin_1017
ok_1016:
w0_1015:
  s_barrier
  buffer_load_dwordx4 v[112:115], v2, s[24:27], s43 offen sc1
  buffer_load_dwordx4 v[116:119], v3, s[24:27], s43 offen offset:1024 sc1
  buffer_load_dwordx4 v[120:123], v2, s[24:27], s43 offen offset:2048 sc1
  buffer_load_dwordx4 v[124:127], v3, s[24:27], s43 offen offset:3072 sc1
  buffer_load_dword v160, v4, s[24:27], s41 offen sc1
  buffer_load_dword v161, v5, s[24:27], s41 offen sc1
  s_waitcnt vmcnt(5)
  ds_write_b128 v10, v[112:115] offset:0
  s_waitcnt vmcnt(4)
  ds_write_b128 v10, v[116:119] offset:1024
  s_waitcnt vmcnt(3)
  ds_write_b128 v10, v[120:123] offset:2048
  s_waitcnt vmcnt(2)
  ds_write_b128 v10, v[124:127] offset:3072
  s_waitcnt lgkmcnt(0)
  s_barrier
  ds_read_b128 v[96:99], v6
  ds_read_b128 v[100:103], v6 offset:8192
  ds_read_b128 v[104:107], v7 offset:8192
  ds_read_b128 v[108:111], v7
  s_waitcnt vmcnt(1) lgkmcnt(1)
  v_cndmask_b32 v104, v104, v160, s[48:49]
  s_waitcnt vmcnt(0) lgkmcnt(0)
  v_cndmask_b32 v108, v108, v161, s[48:49]
  v_mfma_f32_32x32x16_bf16 v[112:127], v[96:99], v[32:35], 0
  v_mfma_f32_32x32x16_bf16 v[128:143], v[96:99], v[48:51], 0
  v_mfma_f32_32x32x16_bf16 v[112:127], v[100:103], v[36:39], v[112:127]
  v_mfma_f32_32x32x16_bf16 v[128:143], v[100:103], v[52:55], v[128:143]
  v_mfma_f32_32x32x16_bf16 v[112:127], v[104:107], v[40:43], v[112:127]
  v_mfma_f32_32x32x16_bf16 v[128:143], v[104:107], v[56:59], v[128:143]
  v_mfma_f32_32x32x16_bf16 v[112:127], v[108:111], v[44:47], v[112:127]
  v_mfma_f32_32x32x16_bf16 v[128:143], v[108:111], v[60:63], v[128:143]
	s_nop 0
  s_nop 10
  v_pk_mul_f32 v[20:21], v[112:113], v[64:65]
  v_pk_mul_f32 v[22:23], v[128:129], v[64:65]
  v_pk_fma_f32 v[20:21], v[128:129], v[80:81], v[20:21]
  v_pk_fma_f32 v[22:23], v[112:113], v[80:81], v[22:23] neg_lo:[1,0,0] neg_hi:[1,0,0]
  v_cvt_pk_bf16_f32 v96, v20, v22
  v_cvt_pk_bf16_f32 v97, v21, v23
  v_pk_mul_f32 v[24:25], v[114:115], v[66:67]
  v_pk_mul_f32 v[26:27], v[130:131], v[66:67]
  v_pk_fma_f32 v[24:25], v[130:131], v[82:83], v[24:25]
  v_pk_fma_f32 v[26:27], v[114:115], v[82:83], v[26:27] neg_lo:[1,0,0] neg_hi:[1,0,0]
  v_cvt_pk_bf16_f32 v98, v24, v26
  v_cvt_pk_bf16_f32 v99, v25, v27
  v_pk_mul_f32 v[20:21], v[116:117], v[68:69]
  v_pk_mul_f32 v[22:23], v[132:133], v[68:69]
  v_pk_fma_f32 v[20:21], v[132:133], v[84:85], v[20:21]
  v_pk_fma_f32 v[22:23], v[116:117], v[84:85], v[22:23] neg_lo:[1,0,0] neg_hi:[1,0,0]
  v_cvt_pk_bf16_f32 v100, v20, v22
  v_cvt_pk_bf16_f32 v101, v21, v23
  v_pk_mul_f32 v[24:25], v[118:119], v[70:71]
  v_pk_mul_f32 v[26:27], v[134:135], v[70:71]
  v_pk_fma_f32 v[24:25], v[134:135], v[86:87], v[24:25]
  v_pk_fma_f32 v[26:27], v[118:119], v[86:87], v[26:27] neg_lo:[1,0,0] neg_hi:[1,0,0]
  v_cvt_pk_bf16_f32 v102, v24, v26
  v_cvt_pk_bf16_f32 v103, v25, v27
  v_pk_mul_f32 v[20:21], v[120:121], v[72:73]
  v_pk_mul_f32 v[22:23], v[136:137], v[72:73]
  v_pk_fma_f32 v[20:21], v[136:137], v[88:89], v[20:21]
  v_pk_fma_f32 v[22:23], v[120:121], v[88:89], v[22:23] neg_lo:[1,0,0] neg_hi:[1,0,0]
  v_cvt_pk_bf16_f32 v104, v20, v22
  v_cvt_pk_bf16_f32 v105, v21, v23
  v_pk_mul_f32 v[24:25], v[122:123], v[74:75]
  v_pk_mul_f32 v[26:27], v[138:139], v[74:75]
  v_pk_fma_f32 v[24:25], v[138:139], v[90:91], v[24:25]
  v_pk_fma_f32 v[26:27], v[122:123], v[90:91], v[26:27] neg_lo:[1,0,0] neg_hi:[1,0,0]
  v_cvt_pk_bf16_f32 v106, v24, v26
  v_cvt_pk_bf16_f32 v107, v25, v27
  v_pk_mul_f32 v[20:21], v[124:125], v[76:77]
  v_pk_mul_f32 v[22:23], v[140:141], v[76:77]
  v_pk_fma_f32 v[20:21], v[140:141], v[92:93], v[20:21]
  v_pk_fma_f32 v[22:23], v[124:125], v[92:93], v[22:23] neg_lo:[1,0,0] neg_hi:[1,0,0]
  v_cvt_pk_bf16_f32 v108, v20, v22
  v_cvt_pk_bf16_f32 v109, v21, v23
  v_pk_mul_f32 v[24:25], v[126:127], v[78:79]
  v_pk_mul_f32 v[26:27], v[142:143], v[78:79]
  v_pk_fma_f32 v[24:25], v[142:143], v[94:95], v[24:25]
  v_pk_fma_f32 v[26:27], v[126:127], v[94:95], v[26:27] neg_lo:[1,0,0] neg_hi:[1,0,0]
  v_cvt_pk_bf16_f32 v110, v24, v26
  v_cvt_pk_bf16_f32 v111, v25, v27
  v_mfma_f32_32x32x16_bf16 v[112:127], v[96:99], v[32:35], 0
  v_mfma_f32_32x32x16_bf16 v[128:143], v[96:99], v[48:51], 0
  v_mfma_f32_32x32x16_bf16 v[112:127], v[100:103], v[36:39], v[112:127]
  v_mfma_f32_32x32x16_bf16 v[128:143], v[100:103], v[52:55], v[128:143]
  v_mfma_f32_32x32x16_bf16 v[112:127], v[104:107], v[40:43], v[112:127]
  v_mfma_f32_32x32x16_bf16 v[128:143], v[104:107], v[56:59], v[128:143]
  v_mfma_f32_32x32x16_bf16 v[112:127], v[108:111], v[44:47], v[112:127]
  v_mfma_f32_32x32x16_bf16 v[128:143], v[108:111], v[60:63], v[128:143]
	s_nop 0
  s_nop 11
  v_cvt_pk_bf16_f32 v144, v128, v129
  v_cvt_pk_bf16_f32 v145, v130, v131
  v_cvt_pk_bf16_f32 v146, v132, v133
  v_cvt_pk_bf16_f32 v147, v134, v135
  s_nop 0
  v_permlane32_swap_b32 v144, v146
  v_permlane32_swap_b32_e64 v145, v147
  buffer_store_dwordx4 v[144:147], v8, s[32:35], s46 offen
  v_cvt_pk_bf16_f32 v148, v136, v137
  v_cvt_pk_bf16_f32 v149, v138, v139
  v_cvt_pk_bf16_f32 v150, v140, v141
  v_cvt_pk_bf16_f32 v151, v142, v143
  s_nop 0
  v_permlane32_swap_b32 v148, v150
  v_permlane32_swap_b32_e64 v149, v151
  buffer_store_dwordx4 v[148:151], v8, s[32:35], s46 offen offset:32
  v_cvt_pk_bf16_f32 v152, v112, v113
  v_cvt_pk_bf16_f32 v153, v114, v115
  v_cvt_pk_bf16_f32 v154, v116, v117
  v_cvt_pk_bf16_f32 v155, v118, v119
  s_nop 0
  v_permlane32_swap_b32 v152, v154
  v_permlane32_swap_b32_e64 v153, v155
  buffer_store_dwordx4 v[152:155], v8, s[32:35], s47 offen
  v_cvt_pk_bf16_f32 v156, v120, v121
  v_cvt_pk_bf16_f32 v157, v122, v123
  v_cvt_pk_bf16_f32 v158, v124, v125
  v_cvt_pk_bf16_f32 v159, v126, v127
  s_nop 0
  v_permlane32_swap_b32 v156, v158
  v_permlane32_swap_b32_e64 v157, v159
  buffer_store_dwordx4 v[156:159], v8, s[32:35], s47 offen offset:32
  s_endpgm
role_a:
  s_waitcnt lgkmcnt(0)
  v_lshrrev_b32_e64 v1, 6, v0
  s_and_b32 s44, s2, 7
  v_readfirstlane_b32 s40, v1
  s_lshr_b32 s45, s2, 3
  s_and_b32 s41, s44, 1
  s_lshl_b32 s41, s41, 3
  s_and_b32 s46, s45, 7
  s_add_u32 s41, s41, s46
  s_lshr_b32 s42, s44, 1
  s_lshl_b32 s42, s42, 2
  s_lshr_b32 s46, s45, 3
  s_add_u32 s42, s42, s46
  s_add_u32 s43, s41, s42
  s_and_b32 s43, s43, 15
  s_mul_i32 s43, s43, 1
  v_and_b32 v1, 63, v0
  s_and_b32 s46, s2, 7
  s_lshr_b32 s47, s2, 3
  s_and_b32 s44, s46, 7
  s_lshl_b32 s44, s44, 1
  s_and_b32 s3, s47, 1
  s_add_u32 s44, s44, s3
  s_lshr_b32 s45, s46, 3
  s_lshl_b32 s45, s45, 4
  s_lshr_b32 s3, s47, 1
  s_add_u32 s45, s45, s3
  s_add_u32 s3, s44, s45
  s_and_b32 s3, s3, 15
  s_mul_i32 s3, s3, 1
  s_mul_i32 s46, s41, 3
  s_mul_i32 s47, s42, 1
  s_add_u32 s43, s46, s47
  s_and_b32 s43, s43, 15
  s_and_b32 s48, s40, 1
  s_lshr_b32 s49, s40, 1
  s_mov_b32 s24, s4
  s_mov_b32 s25, s5
  s_mov_b32 s26, 4194304
  s_mov_b32 s27, 0x00020000
  s_mov_b32 s28, s6
  s_mov_b32 s29, s7
  s_mov_b32 s30, 6291456
  s_mov_b32 s31, 0x00020000
  s_mov_b32 s32, s20
  s_mov_b32 s33, s21
  s_mov_b32 s34, 1048576
  s_mov_b32 s35, 0x00020000
  s_add_u32 s36, s20, 1048576
  s_addc_u32 s37, s21, 0
  s_mov_b32 s38, 131072
  s_mov_b32 s39, 0x00020000
  s_add_u32 s60, s20, 25165824
  s_addc_u32 s61, s21, 0
  s_mov_b32 s62, 49152
  s_mov_b32 s63, 0x00020000
  s_mov_b32 s64, s18
  s_mov_b32 s65, s19
  s_mov_b32 s66, 256
  s_mov_b32 s67, 0x00020000
  s_lshl_b32 s46, s41, 7
  s_lshl_b32 s47, s40, 5
  s_add_u32 s46, s46, s47
  v_lshrrev_b32 v20, 3, v1
  v_add_u32 v20, s46, v20
  v_lshlrev_b32 v20, 11, v20
  v_lshrrev_b32 v21, 4, v1
  v_and_b32 v22, 7, v1
  v_mov_b32 v23, v21
  v_xor_b32 v23, v22, v23
  v_lshlrev_b32 v23, 4, v23
  v_add_u32 v23, v20, v23
  v_add_u32 v2, 0, v23
  v_xor_b32 v23, 4, v21
  v_xor_b32 v23, v22, v23
  v_lshlrev_b32 v23, 4, v23
  v_add_u32_e64 v23, v20, v23
  v_add_u32 v3, 15360, v23
  v_mov_b32 v23, v21
  v_xor_b32 v23, v22, v23
  v_lshlrev_b32 v23, 4, v23
  v_add_u32 v23, v20, v23
  v_add_u32 v4, 30720, v23
  v_xor_b32 v23, 4, v21
  v_xor_b32 v23, v22, v23
  v_lshlrev_b32 v23, 4, v23
  v_add_u32 v23, v20, v23
  v_add_u32 v5, 46080, v23
  v_lshrrev_b32 v20, 4, v1
  s_lshl_b32 s46, s40, 3
  v_add_u32_e64 v21, s46, v20
  s_mov_b32 s47, 6144
  v_mul_lo_u32 v21, v21, s47
  v_bfe_u32 v22, v1, 2, 2
  v_xor_b32 v22, v22, v20
  v_and_b32 v23, 1, v22
  v_lshlrev_b32 v23, 6, v23
  v_lshrrev_b32 v22, 1, v22
  v_lshlrev_b32_e64 v22, 11, v22
  v_add3_u32 v21, v21, v22, v23
  v_and_b32_e64 v22, 3, v1
  v_lshlrev_b32 v22, 4, v22
  s_lshl_b32 s55, s42, 7
  s_add_u32 s46, s55, 2048
  v_add3_u32 v6, v21, v22, s46
  v_add_u32 v7, 23552, v6
  s_lshl_b32 s50, s40, 12
  s_lshl_b32 s51, s40, 11
  s_add_u32 s51, s51, 49152
  s_lshl_b32 s52, s43, 7
  s_lshl_b32 s53, s43, 1
  s_mul_i32 s54, s53, 196608
  s_add_u32 m0, s50, 0
  s_nop 0
  buffer_load_dwordx4 v2, s[24:27], s52 offen lds
  buffer_load_dwordx4 v3, s[24:27], s52 offen offset:1024 lds
  s_add_u32 m0, s51, 0
  s_nop 0
  buffer_load_dwordx4 v6, s[28:31], s54 offen lds
  buffer_load_dwordx4 v7, s[28:31], s54 offen offset:1024 lds
  s_add_u32 s53, s53, 1
  s_and_b32 s53, s53, 31
  s_mul_i32 s54, s53, 196608
  s_add_u32 m0, s50, 0
  s_nop 0
  buffer_load_dwordx4 v4, s[24:27], s52 offen offset:2048 lds
  buffer_load_dwordx4 v5, s[24:27], s52 offen offset:3072 lds
  s_add_u32 s52, s52, 128
  s_and_b32 s52, s52, 0x7ff
  s_add_u32 m0, s51, 8192
	s_nop 0
  s_nop 0
  buffer_load_dwordx4 v6, s[28:31], s54 offen lds
  buffer_load_dwordx4 v7, s[28:31], s54 offen offset:1024 lds
  s_add_u32 s53, s53, 1
  s_and_b32 s53, s53, 31
  s_mul_i32 s54, s53, 196608
  s_add_u32 m0, s50, 16384
  s_nop 0
  buffer_load_dwordx4 v2, s[24:27], s52 offen lds
  buffer_load_dwordx4 v3, s[24:27], s52 offen offset:1024 lds
  s_add_u32 m0, s51, 16384
  s_nop 0
  buffer_load_dwordx4 v6, s[28:31], s54 offen lds
  buffer_load_dwordx4 v7, s[28:31], s54 offen offset:1024 lds
  s_add_u32 s53, s53, 1
  s_and_b32 s53, s53, 31
  s_mul_i32 s54, s53, 196608
  s_add_u32 m0, s50, 16384
	s_nop 0
  s_nop 0
  buffer_load_dwordx4 v4, s[24:27], s52 offen offset:2048 lds
  buffer_load_dwordx4 v5, s[24:27], s52 offen offset:3072 lds
  s_add_u32 s52, s52, 128
  s_and_b32 s52, s52, 0x7ff
  s_add_u32 m0, s51, 24576
	s_nop 0
  s_nop 0
  buffer_load_dwordx4 v6, s[28:31], s54 offen lds
  buffer_load_dwordx4 v7, s[28:31], s54 offen offset:1024 lds
  s_add_u32 s53, s53, 1
  s_and_b32 s53, s53, 31
  s_mul_i32 s54, s53, 196608
  s_add_u32 m0, s50, 32768
  s_nop 0
  buffer_load_dwordx4 v2, s[24:27], s52 offen lds
  buffer_load_dwordx4 v3, s[24:27], s52 offen offset:1024 lds
  v_and_b32 v20, 31, v1
  s_lshl_b32 s46, s49, 6
  v_add_u32 v20, s46, v20
  v_lshlrev_b32 v20, 7, v20
  v_lshrrev_b32 v21, 5, v1
  v_bfe_u32 v22, v1, 1, 3
  v_or_b32 v23, 0, v21
  v_xor_b32 v23, v23, v22
  v_lshlrev_b32 v23, 4, v23
  v_add_u32 v8, v20, v23
  v_or_b32 v23, 2, v21
  v_xor_b32 v23, v23, v22
  v_lshlrev_b32 v23, 4, v23
  v_add_u32 v9, v20, v23
  v_or_b32 v23, 4, v21
  v_xor_b32 v23, v23, v22
  v_lshlrev_b32 v23, 4, v23
  v_add_u32 v10, v20, v23
  v_or_b32 v23, 6, v21
  v_xor_b32 v23, v23, v22
  v_lshlrev_b32 v23, 4, v23
  v_add_u32 v11, v20, v23
  v_lshrrev_b32 v20, 5, v1
  v_lshlrev_b32 v20, 3, v20
  v_bfe_u32 v21, v1, 2, 2
  v_add_u32 v20, v20, v21
  v_lshlrev_b32 v20, 8, v20
  v_and_b32 v22, 3, v1
  v_lshlrev_b32 v22, 3, v22
  v_add_u32_e64 v20, v20, v22
  v_add_u32 v20, 49152, v20
  v_bfe_u32 v22, v1, 4, 1
  v_xor_b32 v23, s48, v21
  v_lshlrev_b32 v23, 6, v23
  v_xor_b32 v24, s49, v22
  v_lshlrev_b32 v24, 5, v24
  v_add3_u32 v12, v20, v23, v24
  s_or_b32 s46, s48, 2
  v_xor_b32 v23, s46, v21
  v_lshlrev_b32 v23, 6, v23
  v_lshlrev_b32 v24, 5, v22
  v_add3_u32 v13, v20, v23, v24
  v_lshrrev_b32 v20, 3, v1
  s_lshl_b32 s46, s40, 3
  v_add_u32_e64 v20, s46, v20
  s_mov_b32 s47, 6144
  v_mul_lo_u32 v20, v20, s47
  v_bfe_u32 v21, v1, 2, 1
  v_bfe_u32 v22, v1, 4, 1
  v_xor_b32 v21, v21, v22
  v_lshlrev_b32 v21, 6, v21
  v_and_b32 v22, 3, v1
  v_lshlrev_b32 v22, 4, v22
  v_add3_u32 v20, v20, v21, v22
  v_add_u32 v16, s55, v20
  v_lshrrev_b32 v20, 5, v1
  v_mul_u32_u24_e64 v20, 8, v20
  v_bfe_u32 v21, v1, 2, 2
  v_add_u32 v20, v20, v21
  v_lshlrev_b32 v20, 7, v20
  v_bfe_u32 v21, v1, 3, 1
  v_xor_b32 v21, s48, v21
  v_lshlrev_b32 v21, 6, v21
  v_bfe_u32 v22, v1, 4, 1
  v_lshlrev_b32_e64 v22, 5, v22
  v_add3_u32 v20, v20, v21, v22
  v_and_b32 v22, 3, v1
  v_lshlrev_b32 v22, 3, v22
  v_add_u32_e64 v20, v20, v22
  v_add_u32 v14, 32768, v20
  s_lshl_b32 s22, s40, 10
  s_add_u32 s22, s22, 32768
  s_lshl_b32 s23, s43, 1
  s_add_u32 s23, s23, 8
  s_and_b32 s23, s23, 31
  s_mul_i32 s23, s23, 196608
  v_lshlrev_b32_e64 v15, 4, v1
  s_waitcnt vmcnt(12)
  s_barrier
  ds_read_b128 v[128:131], v8 offset:0
  ds_read_b128 v[136:139], v8 offset:4096
  ds_read_b64_tr_b16 v[144:145], v12 offset:0
  ds_read_b64_tr_b16 v[146:147], v12 offset:1024
  ds_read_b64_tr_b16 v[152:153], v13 offset:0
  ds_read_b64_tr_b16 v[154:155], v13 offset:1024
  ds_read_b128 v[132:135], v9 offset:0
  ds_read_b128 v[140:143], v9 offset:4096
  ds_read_b64_tr_b16 v[148:149], v12 offset:4096
  ds_read_b64_tr_b16 v[150:151], v12 offset:5120
  ds_read_b64_tr_b16 v[156:157], v13 offset:4096
  ds_read_b64_tr_b16 v[158:159], v13 offset:5120
  s_waitcnt vmcnt(10)
  s_waitcnt lgkmcnt(0)
  s_barrier
  v_mfma_f32_32x32x16_bf16 v[64:79], v[128:131], v[144:147], 0
  ds_read_b128 v[160:163], v10 offset:0
  ds_read_b128 v[168:171], v10 offset:4096
  s_add_u32 m0, s51, 0
  v_mfma_f32_32x32x16_bf16 v[96:111], v[128:131], v[152:155], 0
  ds_read_b64_tr_b16 v[176:177], v12 offset:8192
  ds_read_b64_tr_b16 v[178:179], v12 offset:9216
  buffer_load_dwordx4 v6, s[28:31], s54 offen lds
  v_mfma_f32_32x32x16_bf16 v[80:95], v[136:139], v[144:147], 0
  ds_read_b64_tr_b16 v[184:185], v13 offset:8192
  ds_read_b64_tr_b16 v[186:187], v13 offset:9216
  buffer_load_dwordx4 v7, s[28:31], s54 offen offset:1024 lds
  s_add_u32 s53, s53, 1
  s_and_b32 s53, s53, 31
  s_mul_i32 s54, s53, 196608
  v_mfma_f32_32x32x16_bf16 v[112:127], v[136:139], v[152:155], 0
  ds_read_b128 v[164:167], v11 offset:0
  ds_read_b128 v[172:175], v11 offset:4096
  v_mfma_f32_32x32x16_bf16 v[64:79], v[132:135], v[148:151], v[64:79]
  ds_read_b64_tr_b16 v[180:181], v12 offset:12288
  ds_read_b64_tr_b16 v[182:183], v12 offset:13312
  s_add_u32 m0, s50, 32768
  v_mfma_f32_32x32x16_bf16 v[96:111], v[132:135], v[156:159], v[96:111]
  ds_read_b64_tr_b16 v[188:189], v13 offset:12288
  ds_read_b64_tr_b16 v[190:191], v13 offset:13312
  buffer_load_dwordx4 v4, s[24:27], s52 offen offset:2048 lds
  v_mfma_f32_32x32x16_bf16 v[80:95], v[140:143], v[148:151], v[80:95]
  buffer_load_dwordx4 v5, s[24:27], s52 offen offset:3072 lds
  s_add_u32 s52, s52, 128
  s_and_b32 s52, s52, 0x7ff
  v_mfma_f32_32x32x16_bf16 v[112:127], v[140:143], v[156:159], v[112:127]
  s_waitcnt vmcnt(8)
  s_waitcnt lgkmcnt(0)
	s_nop 0
  s_barrier
  v_mfma_f32_32x32x16_bf16 v[64:79], v[160:163], v[176:179], v[64:79]
  ds_read_b128 v[128:131], v8 offset:16384
  ds_read_b128 v[136:139], v8 offset:20480
  s_add_u32 m0, s51, 8192
  v_mfma_f32_32x32x16_bf16 v[96:111], v[160:163], v[184:187], v[96:111]
  ds_read_b64_tr_b16 v[144:145], v12 offset:16384
  ds_read_b64_tr_b16 v[146:147], v12 offset:17408
  buffer_load_dwordx4 v6, s[28:31], s54 offen lds
  v_mfma_f32_32x32x16_bf16 v[80:95], v[168:171], v[176:179], v[80:95]
  ds_read_b64_tr_b16 v[152:153], v13 offset:16384
  ds_read_b64_tr_b16 v[154:155], v13 offset:17408
  buffer_load_dwordx4 v7, s[28:31], s54 offen offset:1024 lds
  s_add_u32 s53, s53, 1
  s_and_b32 s53, s53, 31
  s_mul_i32 s54, s53, 196608
  v_mfma_f32_32x32x16_bf16 v[112:127], v[168:171], v[184:187], v[112:127]
  ds_read_b128 v[132:135], v9 offset:16384
  ds_read_b128 v[140:143], v9 offset:20480
  v_mfma_f32_32x32x16_bf16 v[64:79], v[164:167], v[180:183], v[64:79]
  ds_read_b64_tr_b16 v[148:149], v12 offset:20480
  ds_read_b64_tr_b16 v[150:151], v12 offset:21504
	s_nop 0
  s_add_u32 m0, s50, 0
  v_mfma_f32_32x32x16_bf16 v[96:111], v[164:167], v[188:191], v[96:111]
  ds_read_b64_tr_b16 v[156:157], v13 offset:20480
  ds_read_b64_tr_b16 v[158:159], v13 offset:21504
  buffer_load_dwordx4 v2, s[24:27], s52 offen lds
  v_mfma_f32_32x32x16_bf16 v[80:95], v[172:175], v[180:183], v[80:95]
  buffer_load_dwordx4 v3, s[24:27], s52 offen offset:1024 lds
  v_mfma_f32_32x32x16_bf16 v[112:127], v[172:175], v[188:191], v[112:127]
  s_waitcnt vmcnt(10)
  s_waitcnt lgkmcnt(0)
	s_nop 0
  s_barrier
  v_mfma_f32_32x32x16_bf16 v[64:79], v[128:131], v[144:147], v[64:79]
  ds_read_b128 v[160:163], v10 offset:16384
  ds_read_b128 v[168:171], v10 offset:20480
  s_add_u32 m0, s51, 16384
  v_mfma_f32_32x32x16_bf16 v[96:111], v[128:131], v[152:155], v[96:111]
  ds_read_b64_tr_b16 v[176:177], v12 offset:24576
  ds_read_b64_tr_b16 v[178:179], v12 offset:25600
  buffer_load_dwordx4 v6, s[28:31], s54 offen lds
  v_mfma_f32_32x32x16_bf16 v[80:95], v[136:139], v[144:147], v[80:95]
  ds_read_b64_tr_b16 v[184:185], v13 offset:24576
  ds_read_b64_tr_b16 v[186:187], v13 offset:25600
  buffer_load_dwordx4 v7, s[28:31], s54 offen offset:1024 lds
  s_add_u32 s53, s53, 1
  s_and_b32 s53, s53, 31
  s_mul_i32 s54, s53, 196608
  v_mfma_f32_32x32x16_bf16 v[112:127], v[136:139], v[152:155], v[112:127]
  ds_read_b128 v[164:167], v11 offset:16384
  ds_read_b128 v[172:175], v11 offset:20480
  v_mfma_f32_32x32x16_bf16 v[64:79], v[132:135], v[148:151], v[64:79]
  ds_read_b64_tr_b16 v[180:181], v12 offset:28672
  ds_read_b64_tr_b16 v[182:183], v12 offset:29696
	s_nop 0
  s_add_u32 m0, s50, 0
  v_mfma_f32_32x32x16_bf16 v[96:111], v[132:135], v[156:159], v[96:111]
  ds_read_b64_tr_b16 v[188:189], v13 offset:28672
  ds_read_b64_tr_b16 v[190:191], v13 offset:29696
  buffer_load_dwordx4 v4, s[24:27], s52 offen offset:2048 lds
  v_mfma_f32_32x32x16_bf16 v[80:95], v[140:143], v[148:151], v[80:95]
  buffer_load_dwordx4 v5, s[24:27], s52 offen offset:3072 lds
  s_add_u32 s52, s52, 128
  s_and_b32 s52, s52, 0x7ff
  v_mfma_f32_32x32x16_bf16 v[112:127], v[140:143], v[156:159], v[112:127]
  s_waitcnt vmcnt(8)
  s_waitcnt lgkmcnt(0)
	s_nop 0
  s_barrier
  v_mfma_f32_32x32x16_bf16 v[64:79], v[160:163], v[176:179], v[64:79]
  ds_read_b128 v[128:131], v8 offset:32768
  ds_read_b128 v[136:139], v8 offset:36864
  s_add_u32 m0, s51, 24576
  v_mfma_f32_32x32x16_bf16 v[96:111], v[160:163], v[184:187], v[96:111]
  ds_read_b64_tr_b16 v[144:145], v12 offset:0
  ds_read_b64_tr_b16 v[146:147], v12 offset:1024
  buffer_load_dwordx4 v6, s[28:31], s54 offen lds
  v_mfma_f32_32x32x16_bf16 v[80:95], v[168:171], v[176:179], v[80:95]
  ds_read_b64_tr_b16 v[152:153], v13 offset:0
  ds_read_b64_tr_b16 v[154:155], v13 offset:1024
  buffer_load_dwordx4 v7, s[28:31], s54 offen offset:1024 lds
  s_add_u32 s53, s53, 1
  s_and_b32 s53, s53, 31
  s_mul_i32 s54, s53, 196608
  v_mfma_f32_32x32x16_bf16 v[112:127], v[168:171], v[184:187], v[112:127]
  ds_read_b128 v[132:135], v9 offset:32768
  ds_read_b128 v[140:143], v9 offset:36864
  v_mfma_f32_32x32x16_bf16 v[64:79], v[164:167], v[180:183], v[64:79]
  ds_read_b64_tr_b16 v[148:149], v12 offset:4096
  ds_read_b64_tr_b16 v[150:151], v12 offset:5120
  s_add_u32 m0, s50, 16384
  v_mfma_f32_32x32x16_bf16 v[96:111], v[164:167], v[188:191], v[96:111]
  ds_read_b64_tr_b16 v[156:157], v13 offset:4096
  ds_read_b64_tr_b16 v[158:159], v13 offset:5120
  buffer_load_dwordx4 v2, s[24:27], s52 offen lds
  v_mfma_f32_32x32x16_bf16 v[80:95], v[172:175], v[180:183], v[80:95]
  buffer_load_dwordx4 v3, s[24:27], s52 offen offset:1024 lds
  v_mfma_f32_32x32x16_bf16 v[112:127], v[172:175], v[188:191], v[112:127]
  s_waitcnt vmcnt(10)
  s_waitcnt lgkmcnt(0)
  s_barrier
  v_mfma_f32_32x32x16_bf16 v[64:79], v[128:131], v[144:147], v[64:79]
  ds_read_b128 v[160:163], v10 offset:32768
  ds_read_b128 v[168:171], v10 offset:36864
  s_add_u32 m0, s51, 0
  v_mfma_f32_32x32x16_bf16 v[96:111], v[128:131], v[152:155], v[96:111]
  ds_read_b64_tr_b16 v[176:177], v12 offset:8192
  ds_read_b64_tr_b16 v[178:179], v12 offset:9216
  buffer_load_dwordx4 v6, s[28:31], s54 offen lds
  v_mfma_f32_32x32x16_bf16 v[80:95], v[136:139], v[144:147], v[80:95]
  ds_read_b64_tr_b16 v[184:185], v13 offset:8192
  ds_read_b64_tr_b16 v[186:187], v13 offset:9216
  buffer_load_dwordx4 v7, s[28:31], s54 offen offset:1024 lds
  s_add_u32 s53, s53, 1
  s_and_b32 s53, s53, 31
  s_mul_i32 s54, s53, 196608
  v_mfma_f32_32x32x16_bf16 v[112:127], v[136:139], v[152:155], v[112:127]
  ds_read_b128 v[164:167], v11 offset:32768
  ds_read_b128 v[172:175], v11 offset:36864
  v_mfma_f32_32x32x16_bf16 v[64:79], v[132:135], v[148:151], v[64:79]
  ds_read_b64_tr_b16 v[180:181], v12 offset:12288
  ds_read_b64_tr_b16 v[182:183], v12 offset:13312
  s_add_u32 m0, s50, 16384
  v_mfma_f32_32x32x16_bf16 v[96:111], v[132:135], v[156:159], v[96:111]
  ds_read_b64_tr_b16 v[188:189], v13 offset:12288
  ds_read_b64_tr_b16 v[190:191], v13 offset:13312
  buffer_load_dwordx4 v4, s[24:27], s52 offen offset:2048 lds
  v_mfma_f32_32x32x16_bf16 v[80:95], v[140:143], v[148:151], v[80:95]
  buffer_load_dwordx4 v5, s[24:27], s52 offen offset:3072 lds
  s_add_u32 s52, s52, 128
  s_and_b32 s52, s52, 0x7ff
  v_mfma_f32_32x32x16_bf16 v[112:127], v[140:143], v[156:159], v[112:127]
  s_waitcnt vmcnt(8)
  s_waitcnt lgkmcnt(0)
	s_nop 0
  s_barrier
  v_mfma_f32_32x32x16_bf16 v[64:79], v[160:163], v[176:179], v[64:79]
  ds_read_b128 v[128:131], v8 offset:0
  ds_read_b128 v[136:139], v8 offset:4096
  s_add_u32 m0, s51, 8192
  v_mfma_f32_32x32x16_bf16 v[96:111], v[160:163], v[184:187], v[96:111]
  ds_read_b64_tr_b16 v[144:145], v12 offset:16384
  ds_read_b64_tr_b16 v[146:147], v12 offset:17408
  buffer_load_dwordx4 v6, s[28:31], s54 offen lds
  v_mfma_f32_32x32x16_bf16 v[80:95], v[168:171], v[176:179], v[80:95]
  ds_read_b64_tr_b16 v[152:153], v13 offset:16384
  ds_read_b64_tr_b16 v[154:155], v13 offset:17408
  buffer_load_dwordx4 v7, s[28:31], s54 offen offset:1024 lds
  s_add_u32 s53, s53, 1
  s_and_b32 s53, s53, 31
  s_mul_i32 s54, s53, 196608
  v_mfma_f32_32x32x16_bf16 v[112:127], v[168:171], v[184:187], v[112:127]
  ds_read_b128 v[132:135], v9 offset:0
  ds_read_b128 v[140:143], v9 offset:4096
	s_nop 0
  s_add_u32 m0, s22, 0
  v_mfma_f32_32x32x16_bf16 v[64:79], v[164:167], v[180:183], v[64:79]
  ds_read_b64_tr_b16 v[148:149], v12 offset:20480
  ds_read_b64_tr_b16 v[150:151], v12 offset:21504
  buffer_load_dwordx4 v16, s[28:31], s23 offen lds
  s_add_u32 s23, s23, 196608
  s_cmp_eq_u32 s23, 6291456
	s_nop 0
  s_cselect_b32 s23, 0, s23
  v_mfma_f32_32x32x16_bf16 v[96:111], v[164:167], v[188:191], v[96:111]
  ds_read_b64_tr_b16 v[156:157], v13 offset:20480
  ds_read_b64_tr_b16 v[158:159], v13 offset:21504
  s_add_u32 m0, s22, 4096
  v_mfma_f32_32x32x16_bf16 v[80:95], v[172:175], v[180:183], v[80:95]
  buffer_load_dwordx4 v16, s[28:31], s23 offen lds
  s_add_u32 s23, s23, 196608
  s_cmp_eq_u32 s23, 6291456
  s_cselect_b32 s23, 0, s23
  v_mfma_f32_32x32x16_bf16 v[112:127], v[172:175], v[188:191], v[112:127]
  s_waitcnt vmcnt(10)
  s_waitcnt lgkmcnt(0)
  s_barrier
  v_mfma_f32_32x32x16_bf16 v[64:79], v[128:131], v[144:147], v[64:79]
  ds_read_b128 v[160:163], v10 offset:0
  ds_read_b128 v[168:171], v10 offset:4096
  s_add_u32 m0, s51, 16384
  v_mfma_f32_32x32x16_bf16 v[96:111], v[128:131], v[152:155], v[96:111]
  ds_read_b64_tr_b16 v[176:177], v12 offset:24576
  ds_read_b64_tr_b16 v[178:179], v12 offset:25600
  buffer_load_dwordx4 v6, s[28:31], s54 offen lds
  v_mfma_f32_32x32x16_bf16 v[80:95], v[136:139], v[144:147], v[80:95]
  ds_read_b64_tr_b16 v[184:185], v13 offset:24576
  ds_read_b64_tr_b16 v[186:187], v13 offset:25600
  v_mfma_f32_32x32x16_bf16 v[112:127], v[136:139], v[152:155], v[112:127]
  ds_read_b128 v[164:167], v11 offset:0
  ds_read_b128 v[172:175], v11 offset:4096
  buffer_load_dwordx4 v7, s[28:31], s54 offen offset:1024 lds
  s_add_u32 s53, s53, 1
  s_and_b32 s53, s53, 31
  s_mul_i32 s54, s53, 196608
  v_mfma_f32_32x32x16_bf16 v[64:79], v[132:135], v[148:151], v[64:79]
  ds_read_b64_tr_b16 v[180:181], v12 offset:28672
  ds_read_b64_tr_b16 v[182:183], v12 offset:29696
  s_add_u32 m0, s22, 8192
  v_mfma_f32_32x32x16_bf16 v[96:111], v[132:135], v[156:159], v[96:111]
  ds_read_b64_tr_b16 v[188:189], v13 offset:28672
  ds_read_b64_tr_b16 v[190:191], v13 offset:29696
  v_mfma_f32_32x32x16_bf16 v[80:95], v[140:143], v[148:151], v[80:95]
  buffer_load_dwordx4 v16, s[28:31], s23 offen lds
  s_add_u32 s23, s23, 196608
  s_cmp_eq_u32 s23, 6291456
  s_cselect_b32 s23, 0, s23
  v_mfma_f32_32x32x16_bf16 v[112:127], v[140:143], v[156:159], v[112:127]
  s_waitcnt vmcnt(4)
  s_waitcnt lgkmcnt(0)
  s_barrier
  v_mfma_f32_32x32x16_bf16 v[64:79], v[160:163], v[176:179], v[64:79]
  ds_read_b128 v[128:131], v8 offset:16384
  ds_read_b128 v[136:139], v8 offset:20480
  ds_read_b64_tr_b16 v[144:145], v12 offset:0
  s_add_u32 m0, s51, 24576
	s_nop 0
  s_nop 0
  buffer_load_dwordx4 v6, s[28:31], s54 offen lds
  v_mfma_f32_32x32x16_bf16 v[96:111], v[160:163], v[184:187], v[96:111]
  ds_read_b64_tr_b16 v[146:147], v12 offset:1024
  ds_read_b64_tr_b16 v[152:153], v13 offset:0
  ds_read_b64_tr_b16 v[154:155], v13 offset:1024
  buffer_load_dwordx4 v7, s[28:31], s54 offen offset:1024 lds
  s_add_u32 s53, s53, 1
  s_and_b32 s53, s53, 31
  s_mul_i32 s54, s53, 196608
  v_mfma_f32_32x32x16_bf16 v[80:95], v[168:171], v[176:179], v[80:95]
  ds_read_b64_tr_b16 v[192:193], v14 offset:0
  ds_read_b64_tr_b16 v[194:195], v14 offset:512
  s_add_u32 m0, s22, 12288
  v_mfma_f32_32x32x16_bf16 v[112:127], v[168:171], v[184:187], v[112:127]
  ds_read_b128 v[132:135], v9 offset:16384
  ds_read_b128 v[140:143], v9 offset:20480
  ds_read_b64_tr_b16 v[148:149], v12 offset:4096
  buffer_load_dwordx4 v16, s[28:31], s23 offen lds
  s_add_u32 s23, s23, 196608
  s_cmp_eq_u32 s23, 6291456
	s_nop 0
  s_cselect_b32 s23, 0, s23
  v_mfma_f32_32x32x16_bf16 v[64:79], v[164:167], v[180:183], v[64:79]
  ds_read_b64_tr_b16 v[150:151], v12 offset:5120
  ds_read_b64_tr_b16 v[156:157], v13 offset:4096
  ds_read_b64_tr_b16 v[158:159], v13 offset:5120
  s_add_u32 m0, s50, 0
  s_nop 0
  buffer_load_dwordx4 v2, s[24:27], s52 offen lds
  v_mfma_f32_32x32x16_bf16 v[96:111], v[164:167], v[188:191], v[96:111]
  ds_read_b64_tr_b16 v[196:197], v14 offset:2048
  ds_read_b64_tr_b16 v[198:199], v14 offset:2560
  buffer_load_dwordx4 v3, s[24:27], s52 offen offset:1024 lds
  v_mfma_f32_32x32x16_bf16 v[80:95], v[172:175], v[180:183], v[80:95]
  buffer_load_dwordx4 v4, s[24:27], s52 offen offset:2048 lds
  v_mfma_f32_32x32x16_bf16 v[112:127], v[172:175], v[188:191], v[112:127]
  buffer_load_dwordx4 v5, s[24:27], s52 offen offset:3072 lds
  s_add_u32 s52, s52, 128
  s_and_b32 s52, s52, 0x7ff
  s_waitcnt vmcnt(10)
  s_waitcnt lgkmcnt(0)
  s_barrier
  v_mfma_f32_32x32x16_bf16 v[64:79], v[128:131], v[144:147], v[64:79]
  ds_read_b128 v[160:163], v10 offset:16384
  ds_read_b128 v[168:171], v10 offset:20480
  s_add_u32 m0, s51, 0
  v_mfma_f32_32x32x16_bf16 v[96:111], v[128:131], v[152:155], v[96:111]
  ds_read_b64_tr_b16 v[176:177], v12 offset:8192
  ds_read_b64_tr_b16 v[178:179], v12 offset:9216
  v_mfma_f32_32x32x16_bf16 v[32:47], v[192:195], v[128:131], 0
  ds_read_b64_tr_b16 v[184:185], v13 offset:8192
  buffer_load_dwordx4 v6, s[28:31], s54 offen lds
  v_mfma_f32_32x32x16_bf16 v[80:95], v[136:139], v[144:147], v[80:95]
  ds_read_b64_tr_b16 v[186:187], v13 offset:9216
  ds_read_b64_tr_b16 v[200:201], v14 offset:4096
  v_mfma_f32_32x32x16_bf16 v[112:127], v[136:139], v[152:155], v[112:127]
  ds_read_b64_tr_b16 v[202:203], v14 offset:4608
  buffer_load_dwordx4 v7, s[28:31], s54 offen offset:1024 lds
  s_add_u32 s53, s53, 1
  s_and_b32 s53, s53, 31
  s_mul_i32 s54, s53, 196608
  v_mfma_f32_32x32x16_bf16 v[48:63], v[192:195], v[136:139], 0
  ds_read_b128 v[164:167], v11 offset:16384
  ds_read_b128 v[172:175], v11 offset:20480
  v_mfma_f32_32x32x16_bf16 v[64:79], v[132:135], v[148:151], v[64:79]
  ds_read_b64_tr_b16 v[180:181], v12 offset:12288
  ds_read_b64_tr_b16 v[182:183], v12 offset:13312
  v_mfma_f32_32x32x16_bf16 v[96:111], v[132:135], v[156:159], v[96:111]
  ds_read_b64_tr_b16 v[188:189], v13 offset:12288
	s_nop 0
  s_add_u32 m0, s22, 0
  v_mfma_f32_32x32x16_bf16 v[32:47], v[196:199], v[132:135], v[32:47]
  ds_read_b64_tr_b16 v[190:191], v13 offset:13312
  ds_read_b64_tr_b16 v[204:205], v14 offset:6144
  v_mfma_f32_32x32x16_bf16 v[80:95], v[140:143], v[148:151], v[80:95]
  ds_read_b64_tr_b16 v[206:207], v14 offset:6656
  buffer_load_dwordx4 v16, s[28:31], s23 offen lds
  s_add_u32 s23, s23, 196608
  s_cmp_eq_u32 s23, 6291456
  s_cselect_b32 s23, 0, s23
  v_mfma_f32_32x32x16_bf16 v[112:127], v[140:143], v[156:159], v[112:127]
  v_mfma_f32_32x32x16_bf16 v[48:63], v[196:199], v[140:143], v[48:63]
  s_waitcnt vmcnt(3)
  s_waitcnt lgkmcnt(0)
  s_barrier
  v_mfma_f32_32x32x16_bf16 v[64:79], v[160:163], v[176:179], v[64:79]
  ds_read_b128 v[128:131], v8 offset:0
  ds_read_b128 v[136:139], v8 offset:4096
  s_add_u32 m0, s51, 8192
  v_mfma_f32_32x32x16_bf16 v[96:111], v[160:163], v[184:187], v[96:111]
  ds_read_b64_tr_b16 v[144:145], v12 offset:16384
  ds_read_b64_tr_b16 v[146:147], v12 offset:17408
  buffer_load_dwordx4 v6, s[28:31], s54 offen lds
  v_mfma_f32_32x32x16_bf16 v[32:47], v[200:203], v[160:163], v[32:47]
  ds_read_b64_tr_b16 v[152:153], v13 offset:16384
  buffer_load_dwordx4 v7, s[28:31], s54 offen offset:1024 lds
  s_add_u32 s53, s53, 1
  s_and_b32 s53, s53, 31
  s_mul_i32 s54, s53, 196608
  v_mfma_f32_32x32x16_bf16 v[80:95], v[168:171], v[176:179], v[80:95]
  ds_read_b64_tr_b16 v[154:155], v13 offset:17408
  ds_read_b64_tr_b16 v[192:193], v14 offset:8192
  s_add_u32 m0, s22, 4096
  v_mfma_f32_32x32x16_bf16 v[112:127], v[168:171], v[184:187], v[112:127]
  ds_read_b64_tr_b16 v[194:195], v14 offset:8704
  buffer_load_dwordx4 v16, s[28:31], s23 offen lds
  s_add_u32 s23, s23, 196608
  s_cmp_eq_u32 s23, 6291456
	s_nop 0
  s_cselect_b32 s23, 0, s23
  v_mfma_f32_32x32x16_bf16 v[48:63], v[200:203], v[168:171], v[48:63]
  ds_read_b128 v[132:135], v9 offset:0
  ds_read_b128 v[140:143], v9 offset:4096
  v_mfma_f32_32x32x16_bf16 v[64:79], v[164:167], v[180:183], v[64:79]
  ds_read_b64_tr_b16 v[148:149], v12 offset:20480
  ds_read_b64_tr_b16 v[150:151], v12 offset:21504
  s_add_u32 m0, s50, 16384
  v_mfma_f32_32x32x16_bf16 v[96:111], v[164:167], v[188:191], v[96:111]
  ds_read_b64_tr_b16 v[156:157], v13 offset:20480
  buffer_load_dwordx4 v2, s[24:27], s52 offen lds
  v_mfma_f32_32x32x16_bf16 v[32:47], v[204:207], v[164:167], v[32:47]
  ds_read_b64_tr_b16 v[158:159], v13 offset:21504
  ds_read_b64_tr_b16 v[196:197], v14 offset:10240
  buffer_load_dwordx4 v3, s[24:27], s52 offen offset:1024 lds
  v_mfma_f32_32x32x16_bf16 v[80:95], v[172:175], v[180:183], v[80:95]
  ds_read_b64_tr_b16 v[198:199], v14 offset:10752
  buffer_load_dwordx4 v4, s[24:27], s52 offen offset:2048 lds
  v_mfma_f32_32x32x16_bf16 v[112:127], v[172:175], v[188:191], v[112:127]
  buffer_load_dwordx4 v5, s[24:27], s52 offen offset:3072 lds
  s_add_u32 s52, s52, 128
  s_and_b32 s52, s52, 0x7ff
  v_mfma_f32_32x32x16_bf16 v[48:63], v[204:207], v[172:175], v[48:63]
  s_waitcnt lgkmcnt(0)
  s_barrier
  v_mfma_f32_32x32x16_bf16 v[64:79], v[128:131], v[144:147], v[64:79]
  ds_read_b128 v[160:163], v10 offset:0
  ds_read_b128 v[168:171], v10 offset:4096
  s_add_u32 m0, s51, 16384
  v_mfma_f32_32x32x16_bf16 v[96:111], v[128:131], v[152:155], v[96:111]
  ds_read_b64_tr_b16 v[176:177], v12 offset:24576
  ds_read_b64_tr_b16 v[178:179], v12 offset:25600
  v_mfma_f32_32x32x16_bf16 v[32:47], v[192:195], v[128:131], v[32:47]
  ds_read_b64_tr_b16 v[184:185], v13 offset:24576
  buffer_load_dwordx4 v6, s[28:31], s54 offen lds
  v_mfma_f32_32x32x16_bf16 v[80:95], v[136:139], v[144:147], v[80:95]
  ds_read_b64_tr_b16 v[186:187], v13 offset:25600
  ds_read_b64_tr_b16 v[200:201], v14 offset:12288
  v_mfma_f32_32x32x16_bf16 v[112:127], v[136:139], v[152:155], v[112:127]
  ds_read_b64_tr_b16 v[202:203], v14 offset:12800
  buffer_load_dwordx4 v7, s[28:31], s54 offen offset:1024 lds
  s_add_u32 s53, s53, 1
  s_and_b32 s53, s53, 31
  s_mul_i32 s54, s53, 196608
  v_mfma_f32_32x32x16_bf16 v[48:63], v[192:195], v[136:139], v[48:63]
  ds_read_b128 v[164:167], v11 offset:0
  ds_read_b128 v[172:175], v11 offset:4096
  v_mfma_f32_32x32x16_bf16 v[64:79], v[132:135], v[148:151], v[64:79]
  ds_read_b64_tr_b16 v[180:181], v12 offset:28672
  ds_read_b64_tr_b16 v[182:183], v12 offset:29696
  v_mfma_f32_32x32x16_bf16 v[96:111], v[132:135], v[156:159], v[96:111]
  ds_read_b64_tr_b16 v[188:189], v13 offset:28672
  s_add_u32 m0, s22, 8192
  v_mfma_f32_32x32x16_bf16 v[32:47], v[196:199], v[132:135], v[32:47]
  ds_read_b64_tr_b16 v[190:191], v13 offset:29696
  ds_read_b64_tr_b16 v[204:205], v14 offset:14336
  v_mfma_f32_32x32x16_bf16 v[80:95], v[140:143], v[148:151], v[80:95]
  ds_read_b64_tr_b16 v[206:207], v14 offset:14848
  buffer_load_dwordx4 v16, s[28:31], s23 offen lds
  s_add_u32 s23, s23, 196608
  s_cmp_eq_u32 s23, 6291456
  s_cselect_b32 s23, 0, s23
  v_mfma_f32_32x32x16_bf16 v[112:127], v[140:143], v[156:159], v[112:127]
  v_mfma_f32_32x32x16_bf16 v[48:63], v[196:199], v[140:143], v[48:63]
  s_waitcnt vmcnt(3)
  s_waitcnt lgkmcnt(0)
  s_barrier
  v_mfma_f32_32x32x16_bf16 v[64:79], v[160:163], v[176:179], v[64:79]
  ds_read_b128 v[128:131], v8 offset:16384
  ds_read_b128 v[136:139], v8 offset:20480
  s_add_u32 m0, s51, 24576
  v_mfma_f32_32x32x16_bf16 v[96:111], v[160:163], v[184:187], v[96:111]
  ds_read_b64_tr_b16 v[144:145], v12 offset:0
  ds_read_b64_tr_b16 v[146:147], v12 offset:1024
  buffer_load_dwordx4 v6, s[28:31], s54 offen lds
  v_mfma_f32_32x32x16_bf16 v[32:47], v[200:203], v[160:163], v[32:47]
  ds_read_b64_tr_b16 v[152:153], v13 offset:0
  buffer_load_dwordx4 v7, s[28:31], s54 offen offset:1024 lds
  s_add_u32 s53, s53, 1
  s_and_b32 s53, s53, 31
  s_mul_i32 s54, s53, 196608
  v_mfma_f32_32x32x16_bf16 v[80:95], v[168:171], v[176:179], v[80:95]
  ds_read_b64_tr_b16 v[154:155], v13 offset:1024
  ds_read_b64_tr_b16 v[192:193], v14 offset:0
  s_add_u32 m0, s22, 12288
  v_mfma_f32_32x32x16_bf16 v[112:127], v[168:171], v[184:187], v[112:127]
  ds_read_b64_tr_b16 v[194:195], v14 offset:512
  buffer_load_dwordx4 v16, s[28:31], s23 offen lds
  s_add_u32 s23, s23, 196608
  s_cmp_eq_u32 s23, 6291456
	s_nop 0
  s_cselect_b32 s23, 0, s23
  v_mfma_f32_32x32x16_bf16 v[48:63], v[200:203], v[168:171], v[48:63]
  ds_read_b128 v[132:135], v9 offset:16384
  ds_read_b128 v[140:143], v9 offset:20480
  v_mfma_f32_32x32x16_bf16 v[64:79], v[164:167], v[180:183], v[64:79]
  ds_read_b64_tr_b16 v[148:149], v12 offset:4096
  ds_read_b64_tr_b16 v[150:151], v12 offset:5120
	s_nop 0
  s_add_u32 m0, s50, 0
  v_mfma_f32_32x32x16_bf16 v[96:111], v[164:167], v[188:191], v[96:111]
  ds_read_b64_tr_b16 v[156:157], v13 offset:4096
  buffer_load_dwordx4 v2, s[24:27], s52 offen lds
  v_mfma_f32_32x32x16_bf16 v[32:47], v[204:207], v[164:167], v[32:47]
  ds_read_b64_tr_b16 v[158:159], v13 offset:5120
  ds_read_b64_tr_b16 v[196:197], v14 offset:2048
  buffer_load_dwordx4 v3, s[24:27], s52 offen offset:1024 lds
  v_mfma_f32_32x32x16_bf16 v[80:95], v[172:175], v[180:183], v[80:95]
  ds_read_b64_tr_b16 v[198:199], v14 offset:2560
  buffer_load_dwordx4 v4, s[24:27], s52 offen offset:2048 lds
  v_mfma_f32_32x32x16_bf16 v[112:127], v[172:175], v[188:191], v[112:127]
  buffer_load_dwordx4 v5, s[24:27], s52 offen offset:3072 lds
  s_add_u32 s52, s52, 128
  s_and_b32 s52, s52, 0x7ff
  v_mfma_f32_32x32x16_bf16 v[48:63], v[204:207], v[172:175], v[48:63]
  s_waitcnt lgkmcnt(0)
  s_barrier
  v_mfma_f32_32x32x16_bf16 v[64:79], v[128:131], v[144:147], v[64:79]
  ds_read_b128 v[160:163], v10 offset:16384
  ds_read_b128 v[168:171], v10 offset:20480
	s_nop 0
  s_add_u32 m0, s51, 0
  v_mfma_f32_32x32x16_bf16 v[96:111], v[128:131], v[152:155], v[96:111]
  ds_read_b64_tr_b16 v[176:177], v12 offset:8192
  ds_read_b64_tr_b16 v[178:179], v12 offset:9216
  v_mfma_f32_32x32x16_bf16 v[32:47], v[192:195], v[128:131], v[32:47]
  ds_read_b64_tr_b16 v[184:185], v13 offset:8192
  buffer_load_dwordx4 v6, s[28:31], s54 offen lds
  v_mfma_f32_32x32x16_bf16 v[80:95], v[136:139], v[144:147], v[80:95]
  ds_read_b64_tr_b16 v[186:187], v13 offset:9216
  ds_read_b64_tr_b16 v[200:201], v14 offset:4096
  v_mfma_f32_32x32x16_bf16 v[112:127], v[136:139], v[152:155], v[112:127]
  ds_read_b64_tr_b16 v[202:203], v14 offset:4608
  buffer_load_dwordx4 v7, s[28:31], s54 offen offset:1024 lds
  s_add_u32 s53, s53, 1
  s_and_b32 s53, s53, 31
  s_mul_i32 s54, s53, 196608
  v_mfma_f32_32x32x16_bf16 v[48:63], v[192:195], v[136:139], v[48:63]
  ds_read_b128 v[164:167], v11 offset:16384
  ds_read_b128 v[172:175], v11 offset:20480
  v_mfma_f32_32x32x16_bf16 v[64:79], v[132:135], v[148:151], v[64:79]
  ds_read_b64_tr_b16 v[180:181], v12 offset:12288
  ds_read_b64_tr_b16 v[182:183], v12 offset:13312
  v_mfma_f32_32x32x16_bf16 v[96:111], v[132:135], v[156:159], v[96:111]
  ds_read_b64_tr_b16 v[188:189], v13 offset:12288
	s_nop 0
  s_add_u32 m0, s22, 0
  v_mfma_f32_32x32x16_bf16 v[32:47], v[196:199], v[132:135], v[32:47]
  ds_read_b64_tr_b16 v[190:191], v13 offset:13312
  ds_read_b64_tr_b16 v[204:205], v14 offset:6144
  v_mfma_f32_32x32x16_bf16 v[80:95], v[140:143], v[148:151], v[80:95]
  ds_read_b64_tr_b16 v[206:207], v14 offset:6656
  buffer_load_dwordx4 v16, s[28:31], s23 offen lds
  s_add_u32 s23, s23, 196608
  s_cmp_eq_u32 s23, 6291456
  s_cselect_b32 s23, 0, s23
  v_mfma_f32_32x32x16_bf16 v[112:127], v[140:143], v[156:159], v[112:127]
  v_mfma_f32_32x32x16_bf16 v[48:63], v[196:199], v[140:143], v[48:63]
  s_waitcnt vmcnt(3)
  s_waitcnt lgkmcnt(0)
  s_barrier
  v_mfma_f32_32x32x16_bf16 v[64:79], v[160:163], v[176:179], v[64:79]
  ds_read_b128 v[128:131], v8 offset:0
  ds_read_b128 v[136:139], v8 offset:4096
  s_add_u32 m0, s51, 8192
  v_mfma_f32_32x32x16_bf16 v[96:111], v[160:163], v[184:187], v[96:111]
  ds_read_b64_tr_b16 v[144:145], v12 offset:16384
  ds_read_b64_tr_b16 v[146:147], v12 offset:17408
  buffer_load_dwordx4 v6, s[28:31], s54 offen lds
  v_mfma_f32_32x32x16_bf16 v[32:47], v[200:203], v[160:163], v[32:47]
  ds_read_b64_tr_b16 v[152:153], v13 offset:16384
  buffer_load_dwordx4 v7, s[28:31], s54 offen offset:1024 lds
  s_add_u32 s53, s53, 1
  s_and_b32 s53, s53, 31
  s_mul_i32 s54, s53, 196608
  v_mfma_f32_32x32x16_bf16 v[80:95], v[168:171], v[176:179], v[80:95]
  ds_read_b64_tr_b16 v[154:155], v13 offset:17408
  ds_read_b64_tr_b16 v[192:193], v14 offset:8192
  s_add_u32 m0, s22, 4096
  v_mfma_f32_32x32x16_bf16 v[112:127], v[168:171], v[184:187], v[112:127]
  ds_read_b64_tr_b16 v[194:195], v14 offset:8704
  buffer_load_dwordx4 v16, s[28:31], s23 offen lds
  s_add_u32 s23, s23, 196608
  s_cmp_eq_u32 s23, 6291456
	s_nop 0
  s_cselect_b32 s23, 0, s23
  v_mfma_f32_32x32x16_bf16 v[48:63], v[200:203], v[168:171], v[48:63]
  ds_read_b128 v[132:135], v9 offset:0
  ds_read_b128 v[140:143], v9 offset:4096
  v_mfma_f32_32x32x16_bf16 v[64:79], v[164:167], v[180:183], v[64:79]
  ds_read_b64_tr_b16 v[148:149], v12 offset:20480
  ds_read_b64_tr_b16 v[150:151], v12 offset:21504
  s_add_u32 m0, s50, 16384
  v_mfma_f32_32x32x16_bf16 v[96:111], v[164:167], v[188:191], v[96:111]
  ds_read_b64_tr_b16 v[156:157], v13 offset:20480
  buffer_load_dwordx4 v2, s[24:27], s52 offen lds
  v_mfma_f32_32x32x16_bf16 v[32:47], v[204:207], v[164:167], v[32:47]
  ds_read_b64_tr_b16 v[158:159], v13 offset:21504
  ds_read_b64_tr_b16 v[196:197], v14 offset:10240
  buffer_load_dwordx4 v3, s[24:27], s52 offen offset:1024 lds
  v_mfma_f32_32x32x16_bf16 v[80:95], v[172:175], v[180:183], v[80:95]
  ds_read_b64_tr_b16 v[198:199], v14 offset:10752
  buffer_load_dwordx4 v4, s[24:27], s52 offen offset:2048 lds
  v_mfma_f32_32x32x16_bf16 v[112:127], v[172:175], v[188:191], v[112:127]
  buffer_load_dwordx4 v5, s[24:27], s52 offen offset:3072 lds
  s_add_u32 s52, s52, 128
  s_and_b32 s52, s52, 0x7ff
  v_mfma_f32_32x32x16_bf16 v[48:63], v[204:207], v[172:175], v[48:63]
  s_waitcnt lgkmcnt(0)
  s_barrier
  v_mfma_f32_32x32x16_bf16 v[64:79], v[128:131], v[144:147], v[64:79]
  ds_read_b128 v[160:163], v10 offset:0
  ds_read_b128 v[168:171], v10 offset:4096
  s_add_u32 m0, s51, 16384
  v_mfma_f32_32x32x16_bf16 v[96:111], v[128:131], v[152:155], v[96:111]
  ds_read_b64_tr_b16 v[176:177], v12 offset:24576
  ds_read_b64_tr_b16 v[178:179], v12 offset:25600
  v_mfma_f32_32x32x16_bf16 v[32:47], v[192:195], v[128:131], v[32:47]
  ds_read_b64_tr_b16 v[184:185], v13 offset:24576
  buffer_load_dwordx4 v6, s[28:31], s54 offen lds
  v_mfma_f32_32x32x16_bf16 v[80:95], v[136:139], v[144:147], v[80:95]
  ds_read_b64_tr_b16 v[186:187], v13 offset:25600
  ds_read_b64_tr_b16 v[200:201], v14 offset:12288
  v_mfma_f32_32x32x16_bf16 v[112:127], v[136:139], v[152:155], v[112:127]
  ds_read_b64_tr_b16 v[202:203], v14 offset:12800
  buffer_load_dwordx4 v7, s[28:31], s54 offen offset:1024 lds
  s_add_u32 s53, s53, 1
  s_and_b32 s53, s53, 31
  s_mul_i32 s54, s53, 196608
  v_mfma_f32_32x32x16_bf16 v[48:63], v[192:195], v[136:139], v[48:63]
  ds_read_b128 v[164:167], v11 offset:0
  ds_read_b128 v[172:175], v11 offset:4096
  v_mfma_f32_32x32x16_bf16 v[64:79], v[132:135], v[148:151], v[64:79]
  ds_read_b64_tr_b16 v[180:181], v12 offset:28672
  ds_read_b64_tr_b16 v[182:183], v12 offset:29696
  v_mfma_f32_32x32x16_bf16 v[96:111], v[132:135], v[156:159], v[96:111]
  ds_read_b64_tr_b16 v[188:189], v13 offset:28672
  s_add_u32 m0, s22, 8192
  v_mfma_f32_32x32x16_bf16 v[32:47], v[196:199], v[132:135], v[32:47]
  ds_read_b64_tr_b16 v[190:191], v13 offset:29696
  ds_read_b64_tr_b16 v[204:205], v14 offset:14336
  v_mfma_f32_32x32x16_bf16 v[80:95], v[140:143], v[148:151], v[80:95]
  ds_read_b64_tr_b16 v[206:207], v14 offset:14848
  buffer_load_dwordx4 v16, s[28:31], s23 offen lds
  s_add_u32 s23, s23, 196608
  s_cmp_eq_u32 s23, 6291456
  s_cselect_b32 s23, 0, s23
  v_mfma_f32_32x32x16_bf16 v[112:127], v[140:143], v[156:159], v[112:127]
  v_mfma_f32_32x32x16_bf16 v[48:63], v[196:199], v[140:143], v[48:63]
  s_waitcnt vmcnt(3)
  s_waitcnt lgkmcnt(0)
  s_barrier
  v_mfma_f32_32x32x16_bf16 v[64:79], v[160:163], v[176:179], v[64:79]
  ds_read_b128 v[128:131], v8 offset:16384
  ds_read_b128 v[136:139], v8 offset:20480
  s_add_u32 m0, s51, 24576
  v_mfma_f32_32x32x16_bf16 v[96:111], v[160:163], v[184:187], v[96:111]
  ds_read_b64_tr_b16 v[144:145], v12 offset:0
  ds_read_b64_tr_b16 v[146:147], v12 offset:1024
  buffer_load_dwordx4 v6, s[28:31], s54 offen lds
  v_mfma_f32_32x32x16_bf16 v[32:47], v[200:203], v[160:163], v[32:47]
  ds_read_b64_tr_b16 v[152:153], v13 offset:0
  buffer_load_dwordx4 v7, s[28:31], s54 offen offset:1024 lds
  s_add_u32 s53, s53, 1
  s_and_b32 s53, s53, 31
  s_mul_i32 s54, s53, 196608
  v_mfma_f32_32x32x16_bf16 v[80:95], v[168:171], v[176:179], v[80:95]
  ds_read_b64_tr_b16 v[154:155], v13 offset:1024
  ds_read_b64_tr_b16 v[192:193], v14 offset:0
  s_add_u32 m0, s22, 12288
  v_mfma_f32_32x32x16_bf16 v[112:127], v[168:171], v[184:187], v[112:127]
  ds_read_b64_tr_b16 v[194:195], v14 offset:512
  buffer_load_dwordx4 v16, s[28:31], s23 offen lds
  s_add_u32 s23, s23, 196608
  s_cmp_eq_u32 s23, 6291456
	s_nop 0
  s_cselect_b32 s23, 0, s23
  v_mfma_f32_32x32x16_bf16 v[48:63], v[200:203], v[168:171], v[48:63]
  ds_read_b128 v[132:135], v9 offset:16384
  ds_read_b128 v[140:143], v9 offset:20480
  v_mfma_f32_32x32x16_bf16 v[64:79], v[164:167], v[180:183], v[64:79]
  ds_read_b64_tr_b16 v[148:149], v12 offset:4096
  ds_read_b64_tr_b16 v[150:151], v12 offset:5120
	s_nop 0
  s_add_u32 m0, s50, 0
  v_mfma_f32_32x32x16_bf16 v[96:111], v[164:167], v[188:191], v[96:111]
  ds_read_b64_tr_b16 v[156:157], v13 offset:4096
  buffer_load_dwordx4 v2, s[24:27], s52 offen lds
  v_mfma_f32_32x32x16_bf16 v[32:47], v[204:207], v[164:167], v[32:47]
  ds_read_b64_tr_b16 v[158:159], v13 offset:5120
  ds_read_b64_tr_b16 v[196:197], v14 offset:2048
  buffer_load_dwordx4 v3, s[24:27], s52 offen offset:1024 lds
  v_mfma_f32_32x32x16_bf16 v[80:95], v[172:175], v[180:183], v[80:95]
  ds_read_b64_tr_b16 v[198:199], v14 offset:2560
  buffer_load_dwordx4 v4, s[24:27], s52 offen offset:2048 lds
  v_mfma_f32_32x32x16_bf16 v[112:127], v[172:175], v[188:191], v[112:127]
  buffer_load_dwordx4 v5, s[24:27], s52 offen offset:3072 lds
  s_add_u32 s52, s52, 128
  s_and_b32 s52, s52, 0x7ff
  v_mfma_f32_32x32x16_bf16 v[48:63], v[204:207], v[172:175], v[48:63]
  s_waitcnt lgkmcnt(0)
  s_barrier
  v_mfma_f32_32x32x16_bf16 v[64:79], v[128:131], v[144:147], v[64:79]
  ds_read_b128 v[160:163], v10 offset:16384
  ds_read_b128 v[168:171], v10 offset:20480
	s_nop 0
  s_add_u32 m0, s51, 0
  v_mfma_f32_32x32x16_bf16 v[96:111], v[128:131], v[152:155], v[96:111]
  ds_read_b64_tr_b16 v[176:177], v12 offset:8192
  ds_read_b64_tr_b16 v[178:179], v12 offset:9216
  v_mfma_f32_32x32x16_bf16 v[32:47], v[192:195], v[128:131], v[32:47]
  ds_read_b64_tr_b16 v[184:185], v13 offset:8192
  buffer_load_dwordx4 v6, s[28:31], s54 offen lds
  v_mfma_f32_32x32x16_bf16 v[80:95], v[136:139], v[144:147], v[80:95]
  ds_read_b64_tr_b16 v[186:187], v13 offset:9216
  ds_read_b64_tr_b16 v[200:201], v14 offset:4096
  v_mfma_f32_32x32x16_bf16 v[112:127], v[136:139], v[152:155], v[112:127]
  ds_read_b64_tr_b16 v[202:203], v14 offset:4608
  buffer_load_dwordx4 v7, s[28:31], s54 offen offset:1024 lds
  s_add_u32 s53, s53, 1
  s_and_b32 s53, s53, 31
  s_mul_i32 s54, s53, 196608
  v_mfma_f32_32x32x16_bf16 v[48:63], v[192:195], v[136:139], v[48:63]
  ds_read_b128 v[164:167], v11 offset:16384
  ds_read_b128 v[172:175], v11 offset:20480
  v_mfma_f32_32x32x16_bf16 v[64:79], v[132:135], v[148:151], v[64:79]
  ds_read_b64_tr_b16 v[180:181], v12 offset:12288
  ds_read_b64_tr_b16 v[182:183], v12 offset:13312
  v_mfma_f32_32x32x16_bf16 v[96:111], v[132:135], v[156:159], v[96:111]
  ds_read_b64_tr_b16 v[188:189], v13 offset:12288
	s_nop 0
  s_add_u32 m0, s22, 0
  v_mfma_f32_32x32x16_bf16 v[32:47], v[196:199], v[132:135], v[32:47]
  ds_read_b64_tr_b16 v[190:191], v13 offset:13312
  ds_read_b64_tr_b16 v[204:205], v14 offset:6144
  v_mfma_f32_32x32x16_bf16 v[80:95], v[140:143], v[148:151], v[80:95]
  ds_read_b64_tr_b16 v[206:207], v14 offset:6656
  buffer_load_dwordx4 v16, s[28:31], s23 offen lds
  s_add_u32 s23, s23, 196608
  s_cmp_eq_u32 s23, 6291456
  s_cselect_b32 s23, 0, s23
  v_mfma_f32_32x32x16_bf16 v[112:127], v[140:143], v[156:159], v[112:127]
  v_mfma_f32_32x32x16_bf16 v[48:63], v[196:199], v[140:143], v[48:63]
  s_waitcnt vmcnt(3)
  s_waitcnt lgkmcnt(0)
  s_barrier
  v_mfma_f32_32x32x16_bf16 v[64:79], v[160:163], v[176:179], v[64:79]
  ds_read_b128 v[128:131], v8 offset:0
  ds_read_b128 v[136:139], v8 offset:4096
  s_add_u32 m0, s51, 8192
  v_mfma_f32_32x32x16_bf16 v[96:111], v[160:163], v[184:187], v[96:111]
  ds_read_b64_tr_b16 v[144:145], v12 offset:16384
  ds_read_b64_tr_b16 v[146:147], v12 offset:17408
  buffer_load_dwordx4 v6, s[28:31], s54 offen lds
  v_mfma_f32_32x32x16_bf16 v[32:47], v[200:203], v[160:163], v[32:47]
  ds_read_b64_tr_b16 v[152:153], v13 offset:16384
  buffer_load_dwordx4 v7, s[28:31], s54 offen offset:1024 lds
  s_add_u32 s53, s53, 1
  s_and_b32 s53, s53, 31
  s_mul_i32 s54, s53, 196608
  v_mfma_f32_32x32x16_bf16 v[80:95], v[168:171], v[176:179], v[80:95]
  ds_read_b64_tr_b16 v[154:155], v13 offset:17408
  ds_read_b64_tr_b16 v[192:193], v14 offset:8192
  s_add_u32 m0, s22, 4096
  v_mfma_f32_32x32x16_bf16 v[112:127], v[168:171], v[184:187], v[112:127]
  ds_read_b64_tr_b16 v[194:195], v14 offset:8704
  buffer_load_dwordx4 v16, s[28:31], s23 offen lds
  s_add_u32 s23, s23, 196608
  s_cmp_eq_u32 s23, 6291456
	s_nop 0
  s_cselect_b32 s23, 0, s23
  v_mfma_f32_32x32x16_bf16 v[48:63], v[200:203], v[168:171], v[48:63]
  ds_read_b128 v[132:135], v9 offset:0
  ds_read_b128 v[140:143], v9 offset:4096
  v_mfma_f32_32x32x16_bf16 v[64:79], v[164:167], v[180:183], v[64:79]
  ds_read_b64_tr_b16 v[148:149], v12 offset:20480
  ds_read_b64_tr_b16 v[150:151], v12 offset:21504
  s_add_u32 m0, s50, 16384
  v_mfma_f32_32x32x16_bf16 v[96:111], v[164:167], v[188:191], v[96:111]
  ds_read_b64_tr_b16 v[156:157], v13 offset:20480
  buffer_load_dwordx4 v2, s[24:27], s52 offen lds
  v_mfma_f32_32x32x16_bf16 v[32:47], v[204:207], v[164:167], v[32:47]
  ds_read_b64_tr_b16 v[158:159], v13 offset:21504
  ds_read_b64_tr_b16 v[196:197], v14 offset:10240
  buffer_load_dwordx4 v3, s[24:27], s52 offen offset:1024 lds
  v_mfma_f32_32x32x16_bf16 v[80:95], v[172:175], v[180:183], v[80:95]
  ds_read_b64_tr_b16 v[198:199], v14 offset:10752
  buffer_load_dwordx4 v4, s[24:27], s52 offen offset:2048 lds
  v_mfma_f32_32x32x16_bf16 v[112:127], v[172:175], v[188:191], v[112:127]
  buffer_load_dwordx4 v5, s[24:27], s52 offen offset:3072 lds
  s_add_u32 s52, s52, 128
  s_and_b32 s52, s52, 0x7ff
  v_mfma_f32_32x32x16_bf16 v[48:63], v[204:207], v[172:175], v[48:63]
  s_waitcnt lgkmcnt(0)
  s_barrier
  v_mfma_f32_32x32x16_bf16 v[64:79], v[128:131], v[144:147], v[64:79]
  ds_read_b128 v[160:163], v10 offset:0
  ds_read_b128 v[168:171], v10 offset:4096
  s_add_u32 m0, s51, 16384
  v_mfma_f32_32x32x16_bf16 v[96:111], v[128:131], v[152:155], v[96:111]
  ds_read_b64_tr_b16 v[176:177], v12 offset:24576
  ds_read_b64_tr_b16 v[178:179], v12 offset:25600
  v_mfma_f32_32x32x16_bf16 v[32:47], v[192:195], v[128:131], v[32:47]
  ds_read_b64_tr_b16 v[184:185], v13 offset:24576
  buffer_load_dwordx4 v6, s[28:31], s54 offen lds
  v_mfma_f32_32x32x16_bf16 v[80:95], v[136:139], v[144:147], v[80:95]
  ds_read_b64_tr_b16 v[186:187], v13 offset:25600
  ds_read_b64_tr_b16 v[200:201], v14 offset:12288
  v_mfma_f32_32x32x16_bf16 v[112:127], v[136:139], v[152:155], v[112:127]
  ds_read_b64_tr_b16 v[202:203], v14 offset:12800
  buffer_load_dwordx4 v7, s[28:31], s54 offen offset:1024 lds
  s_add_u32 s53, s53, 1
  s_and_b32 s53, s53, 31
  s_mul_i32 s54, s53, 196608
  v_mfma_f32_32x32x16_bf16 v[48:63], v[192:195], v[136:139], v[48:63]
  ds_read_b128 v[164:167], v11 offset:0
  ds_read_b128 v[172:175], v11 offset:4096
  v_mfma_f32_32x32x16_bf16 v[64:79], v[132:135], v[148:151], v[64:79]
  ds_read_b64_tr_b16 v[180:181], v12 offset:28672
  ds_read_b64_tr_b16 v[182:183], v12 offset:29696
  v_mfma_f32_32x32x16_bf16 v[96:111], v[132:135], v[156:159], v[96:111]
  ds_read_b64_tr_b16 v[188:189], v13 offset:28672
  s_add_u32 m0, s22, 8192
  v_mfma_f32_32x32x16_bf16 v[32:47], v[196:199], v[132:135], v[32:47]
  ds_read_b64_tr_b16 v[190:191], v13 offset:29696
  ds_read_b64_tr_b16 v[204:205], v14 offset:14336
  v_mfma_f32_32x32x16_bf16 v[80:95], v[140:143], v[148:151], v[80:95]
  ds_read_b64_tr_b16 v[206:207], v14 offset:14848
  buffer_load_dwordx4 v16, s[28:31], s23 offen lds
  s_add_u32 s23, s23, 196608
  s_cmp_eq_u32 s23, 6291456
  s_cselect_b32 s23, 0, s23
  v_mfma_f32_32x32x16_bf16 v[112:127], v[140:143], v[156:159], v[112:127]
  v_mfma_f32_32x32x16_bf16 v[48:63], v[196:199], v[140:143], v[48:63]
  s_waitcnt vmcnt(3)
  s_waitcnt lgkmcnt(0)
  s_barrier
  v_mfma_f32_32x32x16_bf16 v[64:79], v[160:163], v[176:179], v[64:79]
  ds_read_b128 v[128:131], v8 offset:16384
  ds_read_b128 v[136:139], v8 offset:20480
  s_add_u32 m0, s51, 24576
  v_mfma_f32_32x32x16_bf16 v[96:111], v[160:163], v[184:187], v[96:111]
  ds_read_b64_tr_b16 v[144:145], v12 offset:0
  ds_read_b64_tr_b16 v[146:147], v12 offset:1024
  buffer_load_dwordx4 v6, s[28:31], s54 offen lds
  v_mfma_f32_32x32x16_bf16 v[32:47], v[200:203], v[160:163], v[32:47]
  ds_read_b64_tr_b16 v[152:153], v13 offset:0
  buffer_load_dwordx4 v7, s[28:31], s54 offen offset:1024 lds
  s_add_u32 s53, s53, 1
  s_and_b32 s53, s53, 31
  s_mul_i32 s54, s53, 196608
  v_mfma_f32_32x32x16_bf16 v[80:95], v[168:171], v[176:179], v[80:95]
  ds_read_b64_tr_b16 v[154:155], v13 offset:1024
  ds_read_b64_tr_b16 v[192:193], v14 offset:0
  s_add_u32 m0, s22, 12288
  v_mfma_f32_32x32x16_bf16 v[112:127], v[168:171], v[184:187], v[112:127]
  ds_read_b64_tr_b16 v[194:195], v14 offset:512
  buffer_load_dwordx4 v16, s[28:31], s23 offen lds
  s_add_u32 s23, s23, 196608
  s_cmp_eq_u32 s23, 6291456
	s_nop 0
  s_cselect_b32 s23, 0, s23
  v_mfma_f32_32x32x16_bf16 v[48:63], v[200:203], v[168:171], v[48:63]
  ds_read_b128 v[132:135], v9 offset:16384
  ds_read_b128 v[140:143], v9 offset:20480
  v_mfma_f32_32x32x16_bf16 v[64:79], v[164:167], v[180:183], v[64:79]
  ds_read_b64_tr_b16 v[148:149], v12 offset:4096
  ds_read_b64_tr_b16 v[150:151], v12 offset:5120
	s_nop 0
  s_add_u32 m0, s50, 0
  v_mfma_f32_32x32x16_bf16 v[96:111], v[164:167], v[188:191], v[96:111]
  ds_read_b64_tr_b16 v[156:157], v13 offset:4096
  buffer_load_dwordx4 v2, s[24:27], s52 offen lds
  v_mfma_f32_32x32x16_bf16 v[32:47], v[204:207], v[164:167], v[32:47]
  ds_read_b64_tr_b16 v[158:159], v13 offset:5120
  ds_read_b64_tr_b16 v[196:197], v14 offset:2048
  buffer_load_dwordx4 v3, s[24:27], s52 offen offset:1024 lds
  v_mfma_f32_32x32x16_bf16 v[80:95], v[172:175], v[180:183], v[80:95]
  ds_read_b64_tr_b16 v[198:199], v14 offset:2560
  buffer_load_dwordx4 v4, s[24:27], s52 offen offset:2048 lds
  v_mfma_f32_32x32x16_bf16 v[112:127], v[172:175], v[188:191], v[112:127]
  buffer_load_dwordx4 v5, s[24:27], s52 offen offset:3072 lds
  s_add_u32 s52, s52, 128
  s_and_b32 s52, s52, 0x7ff
  v_mfma_f32_32x32x16_bf16 v[48:63], v[204:207], v[172:175], v[48:63]
  s_waitcnt lgkmcnt(0)
  s_barrier
  v_mfma_f32_32x32x16_bf16 v[64:79], v[128:131], v[144:147], v[64:79]
  ds_read_b128 v[160:163], v10 offset:16384
  ds_read_b128 v[168:171], v10 offset:20480
	s_nop 0
  s_add_u32 m0, s51, 0
  v_mfma_f32_32x32x16_bf16 v[96:111], v[128:131], v[152:155], v[96:111]
  ds_read_b64_tr_b16 v[176:177], v12 offset:8192
  ds_read_b64_tr_b16 v[178:179], v12 offset:9216
  v_mfma_f32_32x32x16_bf16 v[32:47], v[192:195], v[128:131], v[32:47]
  ds_read_b64_tr_b16 v[184:185], v13 offset:8192
  buffer_load_dwordx4 v6, s[28:31], s54 offen lds
  v_mfma_f32_32x32x16_bf16 v[80:95], v[136:139], v[144:147], v[80:95]
  ds_read_b64_tr_b16 v[186:187], v13 offset:9216
  ds_read_b64_tr_b16 v[200:201], v14 offset:4096
  v_mfma_f32_32x32x16_bf16 v[112:127], v[136:139], v[152:155], v[112:127]
  ds_read_b64_tr_b16 v[202:203], v14 offset:4608
  buffer_load_dwordx4 v7, s[28:31], s54 offen offset:1024 lds
  s_add_u32 s53, s53, 1
  s_and_b32 s53, s53, 31
  s_mul_i32 s54, s53, 196608
  v_mfma_f32_32x32x16_bf16 v[48:63], v[192:195], v[136:139], v[48:63]
  ds_read_b128 v[164:167], v11 offset:16384
  ds_read_b128 v[172:175], v11 offset:20480
  v_mfma_f32_32x32x16_bf16 v[64:79], v[132:135], v[148:151], v[64:79]
  ds_read_b64_tr_b16 v[180:181], v12 offset:12288
  ds_read_b64_tr_b16 v[182:183], v12 offset:13312
  v_mfma_f32_32x32x16_bf16 v[96:111], v[132:135], v[156:159], v[96:111]
  ds_read_b64_tr_b16 v[188:189], v13 offset:12288
	s_nop 0
  s_add_u32 m0, s22, 0
  v_mfma_f32_32x32x16_bf16 v[32:47], v[196:199], v[132:135], v[32:47]
  ds_read_b64_tr_b16 v[190:191], v13 offset:13312
  ds_read_b64_tr_b16 v[204:205], v14 offset:6144
  v_mfma_f32_32x32x16_bf16 v[80:95], v[140:143], v[148:151], v[80:95]
  ds_read_b64_tr_b16 v[206:207], v14 offset:6656
  buffer_load_dwordx4 v16, s[28:31], s23 offen lds
  s_add_u32 s23, s23, 196608
  s_cmp_eq_u32 s23, 6291456
  s_cselect_b32 s23, 0, s23
  v_mfma_f32_32x32x16_bf16 v[112:127], v[140:143], v[156:159], v[112:127]
  v_mfma_f32_32x32x16_bf16 v[48:63], v[196:199], v[140:143], v[48:63]
  s_waitcnt vmcnt(3)
  s_waitcnt lgkmcnt(0)
  s_barrier
  v_mfma_f32_32x32x16_bf16 v[64:79], v[160:163], v[176:179], v[64:79]
  ds_read_b128 v[128:131], v8 offset:0
  ds_read_b128 v[136:139], v8 offset:4096
  s_add_u32 m0, s51, 8192
  v_mfma_f32_32x32x16_bf16 v[96:111], v[160:163], v[184:187], v[96:111]
  ds_read_b64_tr_b16 v[144:145], v12 offset:16384
  ds_read_b64_tr_b16 v[146:147], v12 offset:17408
  buffer_load_dwordx4 v6, s[28:31], s54 offen lds
  v_mfma_f32_32x32x16_bf16 v[32:47], v[200:203], v[160:163], v[32:47]
  ds_read_b64_tr_b16 v[152:153], v13 offset:16384
  buffer_load_dwordx4 v7, s[28:31], s54 offen offset:1024 lds
  s_add_u32 s53, s53, 1
  s_and_b32 s53, s53, 31
  s_mul_i32 s54, s53, 196608
  v_mfma_f32_32x32x16_bf16 v[80:95], v[168:171], v[176:179], v[80:95]
  ds_read_b64_tr_b16 v[154:155], v13 offset:17408
  ds_read_b64_tr_b16 v[192:193], v14 offset:8192
  s_add_u32 m0, s22, 4096
  v_mfma_f32_32x32x16_bf16 v[112:127], v[168:171], v[184:187], v[112:127]
  ds_read_b64_tr_b16 v[194:195], v14 offset:8704
  buffer_load_dwordx4 v16, s[28:31], s23 offen lds
  s_add_u32 s23, s23, 196608
  s_cmp_eq_u32 s23, 6291456
	s_nop 0
  s_cselect_b32 s23, 0, s23
  v_mfma_f32_32x32x16_bf16 v[48:63], v[200:203], v[168:171], v[48:63]
  ds_read_b128 v[132:135], v9 offset:0
  ds_read_b128 v[140:143], v9 offset:4096
  v_mfma_f32_32x32x16_bf16 v[64:79], v[164:167], v[180:183], v[64:79]
  ds_read_b64_tr_b16 v[148:149], v12 offset:20480
  ds_read_b64_tr_b16 v[150:151], v12 offset:21504
  s_add_u32 m0, s50, 16384
  v_mfma_f32_32x32x16_bf16 v[96:111], v[164:167], v[188:191], v[96:111]
  ds_read_b64_tr_b16 v[156:157], v13 offset:20480
  buffer_load_dwordx4 v2, s[24:27], s52 offen lds
  v_mfma_f32_32x32x16_bf16 v[32:47], v[204:207], v[164:167], v[32:47]
  ds_read_b64_tr_b16 v[158:159], v13 offset:21504
  ds_read_b64_tr_b16 v[196:197], v14 offset:10240
  buffer_load_dwordx4 v3, s[24:27], s52 offen offset:1024 lds
  v_mfma_f32_32x32x16_bf16 v[80:95], v[172:175], v[180:183], v[80:95]
  ds_read_b64_tr_b16 v[198:199], v14 offset:10752
  buffer_load_dwordx4 v4, s[24:27], s52 offen offset:2048 lds
  v_mfma_f32_32x32x16_bf16 v[112:127], v[172:175], v[188:191], v[112:127]
  buffer_load_dwordx4 v5, s[24:27], s52 offen offset:3072 lds
  s_add_u32 s52, s52, 128
  s_and_b32 s52, s52, 0x7ff
  v_mfma_f32_32x32x16_bf16 v[48:63], v[204:207], v[172:175], v[48:63]
  s_waitcnt lgkmcnt(0)
  s_barrier
  v_mfma_f32_32x32x16_bf16 v[64:79], v[128:131], v[144:147], v[64:79]
  ds_read_b128 v[160:163], v10 offset:0
  ds_read_b128 v[168:171], v10 offset:4096
  s_add_u32 m0, s51, 16384
  v_mfma_f32_32x32x16_bf16 v[96:111], v[128:131], v[152:155], v[96:111]
  ds_read_b64_tr_b16 v[176:177], v12 offset:24576
  ds_read_b64_tr_b16 v[178:179], v12 offset:25600
  v_mfma_f32_32x32x16_bf16 v[32:47], v[192:195], v[128:131], v[32:47]
  ds_read_b64_tr_b16 v[184:185], v13 offset:24576
  buffer_load_dwordx4 v6, s[28:31], s54 offen lds
  v_mfma_f32_32x32x16_bf16 v[80:95], v[136:139], v[144:147], v[80:95]
  ds_read_b64_tr_b16 v[186:187], v13 offset:25600
  ds_read_b64_tr_b16 v[200:201], v14 offset:12288
  v_mfma_f32_32x32x16_bf16 v[112:127], v[136:139], v[152:155], v[112:127]
  ds_read_b64_tr_b16 v[202:203], v14 offset:12800
  buffer_load_dwordx4 v7, s[28:31], s54 offen offset:1024 lds
  s_add_u32 s53, s53, 1
  s_and_b32 s53, s53, 31
  s_mul_i32 s54, s53, 196608
  v_mfma_f32_32x32x16_bf16 v[48:63], v[192:195], v[136:139], v[48:63]
  ds_read_b128 v[164:167], v11 offset:0
  ds_read_b128 v[172:175], v11 offset:4096
  v_mfma_f32_32x32x16_bf16 v[64:79], v[132:135], v[148:151], v[64:79]
  ds_read_b64_tr_b16 v[180:181], v12 offset:28672
  ds_read_b64_tr_b16 v[182:183], v12 offset:29696
  v_mfma_f32_32x32x16_bf16 v[96:111], v[132:135], v[156:159], v[96:111]
  ds_read_b64_tr_b16 v[188:189], v13 offset:28672
  s_add_u32 m0, s22, 8192
  v_mfma_f32_32x32x16_bf16 v[32:47], v[196:199], v[132:135], v[32:47]
  ds_read_b64_tr_b16 v[190:191], v13 offset:29696
  ds_read_b64_tr_b16 v[204:205], v14 offset:14336
  v_mfma_f32_32x32x16_bf16 v[80:95], v[140:143], v[148:151], v[80:95]
  ds_read_b64_tr_b16 v[206:207], v14 offset:14848
  buffer_load_dwordx4 v16, s[28:31], s23 offen lds
  s_add_u32 s23, s23, 196608
  s_cmp_eq_u32 s23, 6291456
  s_cselect_b32 s23, 0, s23
  v_mfma_f32_32x32x16_bf16 v[112:127], v[140:143], v[156:159], v[112:127]
  v_mfma_f32_32x32x16_bf16 v[48:63], v[196:199], v[140:143], v[48:63]
  s_waitcnt vmcnt(3)
  s_waitcnt lgkmcnt(0)
  s_barrier
  v_mfma_f32_32x32x16_bf16 v[64:79], v[160:163], v[176:179], v[64:79]
  ds_read_b128 v[128:131], v8 offset:16384
  ds_read_b128 v[136:139], v8 offset:20480
  s_add_u32 m0, s51, 24576
  v_mfma_f32_32x32x16_bf16 v[96:111], v[160:163], v[184:187], v[96:111]
  ds_read_b64_tr_b16 v[144:145], v12 offset:0
  ds_read_b64_tr_b16 v[146:147], v12 offset:1024
  buffer_load_dwordx4 v6, s[28:31], s54 offen lds
  v_mfma_f32_32x32x16_bf16 v[32:47], v[200:203], v[160:163], v[32:47]
  ds_read_b64_tr_b16 v[152:153], v13 offset:0
  buffer_load_dwordx4 v7, s[28:31], s54 offen offset:1024 lds
  s_add_u32 s53, s53, 1
  s_and_b32 s53, s53, 31
  s_mul_i32 s54, s53, 196608
  v_mfma_f32_32x32x16_bf16 v[80:95], v[168:171], v[176:179], v[80:95]
  ds_read_b64_tr_b16 v[154:155], v13 offset:1024
  ds_read_b64_tr_b16 v[192:193], v14 offset:0
  s_add_u32 m0, s22, 12288
  v_mfma_f32_32x32x16_bf16 v[112:127], v[168:171], v[184:187], v[112:127]
  ds_read_b64_tr_b16 v[194:195], v14 offset:512
  buffer_load_dwordx4 v16, s[28:31], s23 offen lds
  s_add_u32 s23, s23, 196608
  s_cmp_eq_u32 s23, 6291456
	s_nop 0
  s_cselect_b32 s23, 0, s23
  v_mfma_f32_32x32x16_bf16 v[48:63], v[200:203], v[168:171], v[48:63]
  ds_read_b128 v[132:135], v9 offset:16384
  ds_read_b128 v[140:143], v9 offset:20480
  v_mfma_f32_32x32x16_bf16 v[64:79], v[164:167], v[180:183], v[64:79]
  ds_read_b64_tr_b16 v[148:149], v12 offset:4096
  ds_read_b64_tr_b16 v[150:151], v12 offset:5120
	s_nop 0
  s_add_u32 m0, s50, 0
  v_mfma_f32_32x32x16_bf16 v[96:111], v[164:167], v[188:191], v[96:111]
  ds_read_b64_tr_b16 v[156:157], v13 offset:4096
  buffer_load_dwordx4 v2, s[24:27], s52 offen lds
  v_mfma_f32_32x32x16_bf16 v[32:47], v[204:207], v[164:167], v[32:47]
  ds_read_b64_tr_b16 v[158:159], v13 offset:5120
  ds_read_b64_tr_b16 v[196:197], v14 offset:2048
  buffer_load_dwordx4 v3, s[24:27], s52 offen offset:1024 lds
  v_mfma_f32_32x32x16_bf16 v[80:95], v[172:175], v[180:183], v[80:95]
  ds_read_b64_tr_b16 v[198:199], v14 offset:2560
  buffer_load_dwordx4 v4, s[24:27], s52 offen offset:2048 lds
  v_mfma_f32_32x32x16_bf16 v[112:127], v[172:175], v[188:191], v[112:127]
  buffer_load_dwordx4 v5, s[24:27], s52 offen offset:3072 lds
  s_add_u32 s52, s52, 128
  s_and_b32 s52, s52, 0x7ff
  v_mfma_f32_32x32x16_bf16 v[48:63], v[204:207], v[172:175], v[48:63]
  s_waitcnt lgkmcnt(0)
  s_barrier
  v_mfma_f32_32x32x16_bf16 v[64:79], v[128:131], v[144:147], v[64:79]
  ds_read_b128 v[160:163], v10 offset:16384
  ds_read_b128 v[168:171], v10 offset:20480
	s_nop 0
  s_add_u32 m0, s51, 0
  v_mfma_f32_32x32x16_bf16 v[96:111], v[128:131], v[152:155], v[96:111]
  ds_read_b64_tr_b16 v[176:177], v12 offset:8192
  ds_read_b64_tr_b16 v[178:179], v12 offset:9216
  v_mfma_f32_32x32x16_bf16 v[32:47], v[192:195], v[128:131], v[32:47]
  ds_read_b64_tr_b16 v[184:185], v13 offset:8192
  buffer_load_dwordx4 v6, s[28:31], s54 offen lds
  v_mfma_f32_32x32x16_bf16 v[80:95], v[136:139], v[144:147], v[80:95]
  ds_read_b64_tr_b16 v[186:187], v13 offset:9216
  ds_read_b64_tr_b16 v[200:201], v14 offset:4096
  v_mfma_f32_32x32x16_bf16 v[112:127], v[136:139], v[152:155], v[112:127]
  ds_read_b64_tr_b16 v[202:203], v14 offset:4608
  buffer_load_dwordx4 v7, s[28:31], s54 offen offset:1024 lds
  s_add_u32 s53, s53, 1
  s_and_b32 s53, s53, 31
  s_mul_i32 s54, s53, 196608
  v_mfma_f32_32x32x16_bf16 v[48:63], v[192:195], v[136:139], v[48:63]
  ds_read_b128 v[164:167], v11 offset:16384
  ds_read_b128 v[172:175], v11 offset:20480
  v_mfma_f32_32x32x16_bf16 v[64:79], v[132:135], v[148:151], v[64:79]
  ds_read_b64_tr_b16 v[180:181], v12 offset:12288
  ds_read_b64_tr_b16 v[182:183], v12 offset:13312
  v_mfma_f32_32x32x16_bf16 v[96:111], v[132:135], v[156:159], v[96:111]
  ds_read_b64_tr_b16 v[188:189], v13 offset:12288
	s_nop 0
  s_add_u32 m0, s22, 0
  v_mfma_f32_32x32x16_bf16 v[32:47], v[196:199], v[132:135], v[32:47]
  ds_read_b64_tr_b16 v[190:191], v13 offset:13312
  ds_read_b64_tr_b16 v[204:205], v14 offset:6144
  v_mfma_f32_32x32x16_bf16 v[80:95], v[140:143], v[148:151], v[80:95]
  ds_read_b64_tr_b16 v[206:207], v14 offset:6656
  buffer_load_dwordx4 v16, s[28:31], s23 offen lds
  s_add_u32 s23, s23, 196608
  s_cmp_eq_u32 s23, 6291456
  s_cselect_b32 s23, 0, s23
  v_mfma_f32_32x32x16_bf16 v[112:127], v[140:143], v[156:159], v[112:127]
  v_mfma_f32_32x32x16_bf16 v[48:63], v[196:199], v[140:143], v[48:63]
  s_waitcnt vmcnt(3)
  s_waitcnt lgkmcnt(0)
  s_barrier
  v_mfma_f32_32x32x16_bf16 v[64:79], v[160:163], v[176:179], v[64:79]
  ds_read_b128 v[128:131], v8 offset:0
  ds_read_b128 v[136:139], v8 offset:4096
  s_add_u32 m0, s51, 8192
  v_mfma_f32_32x32x16_bf16 v[96:111], v[160:163], v[184:187], v[96:111]
  ds_read_b64_tr_b16 v[144:145], v12 offset:16384
  ds_read_b64_tr_b16 v[146:147], v12 offset:17408
  buffer_load_dwordx4 v6, s[28:31], s54 offen lds
  v_mfma_f32_32x32x16_bf16 v[32:47], v[200:203], v[160:163], v[32:47]
  ds_read_b64_tr_b16 v[152:153], v13 offset:16384
  buffer_load_dwordx4 v7, s[28:31], s54 offen offset:1024 lds
  s_add_u32 s53, s53, 1
  s_and_b32 s53, s53, 31
  s_mul_i32 s54, s53, 196608
  v_mfma_f32_32x32x16_bf16 v[80:95], v[168:171], v[176:179], v[80:95]
  ds_read_b64_tr_b16 v[154:155], v13 offset:17408
  ds_read_b64_tr_b16 v[192:193], v14 offset:8192
  s_add_u32 m0, s22, 4096
  v_mfma_f32_32x32x16_bf16 v[112:127], v[168:171], v[184:187], v[112:127]
  ds_read_b64_tr_b16 v[194:195], v14 offset:8704
  buffer_load_dwordx4 v16, s[28:31], s23 offen lds
  s_add_u32 s23, s23, 196608
  s_cmp_eq_u32 s23, 6291456
	s_nop 0
  s_cselect_b32 s23, 0, s23
  v_mfma_f32_32x32x16_bf16 v[48:63], v[200:203], v[168:171], v[48:63]
  ds_read_b128 v[132:135], v9 offset:0
  ds_read_b128 v[140:143], v9 offset:4096
  v_mfma_f32_32x32x16_bf16 v[64:79], v[164:167], v[180:183], v[64:79]
  ds_read_b64_tr_b16 v[148:149], v12 offset:20480
  ds_read_b64_tr_b16 v[150:151], v12 offset:21504
  s_add_u32 m0, s50, 16384
  v_mfma_f32_32x32x16_bf16 v[96:111], v[164:167], v[188:191], v[96:111]
  ds_read_b64_tr_b16 v[156:157], v13 offset:20480
  buffer_load_dwordx4 v2, s[24:27], s52 offen lds
  v_mfma_f32_32x32x16_bf16 v[32:47], v[204:207], v[164:167], v[32:47]
  ds_read_b64_tr_b16 v[158:159], v13 offset:21504
  ds_read_b64_tr_b16 v[196:197], v14 offset:10240
  buffer_load_dwordx4 v3, s[24:27], s52 offen offset:1024 lds
  v_mfma_f32_32x32x16_bf16 v[80:95], v[172:175], v[180:183], v[80:95]
  ds_read_b64_tr_b16 v[198:199], v14 offset:10752
  buffer_load_dwordx4 v4, s[24:27], s52 offen offset:2048 lds
  v_mfma_f32_32x32x16_bf16 v[112:127], v[172:175], v[188:191], v[112:127]
  buffer_load_dwordx4 v5, s[24:27], s52 offen offset:3072 lds
  s_add_u32 s52, s52, 128
  s_and_b32 s52, s52, 0x7ff
  v_mfma_f32_32x32x16_bf16 v[48:63], v[204:207], v[172:175], v[48:63]
  s_waitcnt lgkmcnt(0)
  s_barrier
  v_mfma_f32_32x32x16_bf16 v[64:79], v[128:131], v[144:147], v[64:79]
  ds_read_b128 v[160:163], v10 offset:0
  ds_read_b128 v[168:171], v10 offset:4096
  s_add_u32 m0, s51, 16384
  v_mfma_f32_32x32x16_bf16 v[96:111], v[128:131], v[152:155], v[96:111]
  ds_read_b64_tr_b16 v[176:177], v12 offset:24576
  ds_read_b64_tr_b16 v[178:179], v12 offset:25600
  v_mfma_f32_32x32x16_bf16 v[32:47], v[192:195], v[128:131], v[32:47]
  ds_read_b64_tr_b16 v[184:185], v13 offset:24576
  buffer_load_dwordx4 v6, s[28:31], s54 offen lds
  v_mfma_f32_32x32x16_bf16 v[80:95], v[136:139], v[144:147], v[80:95]
  ds_read_b64_tr_b16 v[186:187], v13 offset:25600
  ds_read_b64_tr_b16 v[200:201], v14 offset:12288
  v_mfma_f32_32x32x16_bf16 v[112:127], v[136:139], v[152:155], v[112:127]
  ds_read_b64_tr_b16 v[202:203], v14 offset:12800
  buffer_load_dwordx4 v7, s[28:31], s54 offen offset:1024 lds
  s_add_u32 s53, s53, 1
  s_and_b32 s53, s53, 31
  s_mul_i32 s54, s53, 196608
  v_mfma_f32_32x32x16_bf16 v[48:63], v[192:195], v[136:139], v[48:63]
  ds_read_b128 v[164:167], v11 offset:0
  ds_read_b128 v[172:175], v11 offset:4096
  v_mfma_f32_32x32x16_bf16 v[64:79], v[132:135], v[148:151], v[64:79]
  ds_read_b64_tr_b16 v[180:181], v12 offset:28672
  ds_read_b64_tr_b16 v[182:183], v12 offset:29696
  v_mfma_f32_32x32x16_bf16 v[96:111], v[132:135], v[156:159], v[96:111]
  ds_read_b64_tr_b16 v[188:189], v13 offset:28672
  s_add_u32 m0, s22, 8192
  v_mfma_f32_32x32x16_bf16 v[32:47], v[196:199], v[132:135], v[32:47]
  ds_read_b64_tr_b16 v[190:191], v13 offset:29696
  ds_read_b64_tr_b16 v[204:205], v14 offset:14336
  v_mfma_f32_32x32x16_bf16 v[80:95], v[140:143], v[148:151], v[80:95]
  ds_read_b64_tr_b16 v[206:207], v14 offset:14848
  buffer_load_dwordx4 v16, s[28:31], s23 offen lds
  s_add_u32 s23, s23, 196608
  s_cmp_eq_u32 s23, 6291456
  s_cselect_b32 s23, 0, s23
  v_mfma_f32_32x32x16_bf16 v[112:127], v[140:143], v[156:159], v[112:127]
  v_mfma_f32_32x32x16_bf16 v[48:63], v[196:199], v[140:143], v[48:63]
  s_waitcnt vmcnt(3)
  s_waitcnt lgkmcnt(0)
  s_barrier
  v_mfma_f32_32x32x16_bf16 v[64:79], v[160:163], v[176:179], v[64:79]
  ds_read_b128 v[128:131], v8 offset:16384
  ds_read_b128 v[136:139], v8 offset:20480
  s_add_u32 m0, s51, 24576
  v_mfma_f32_32x32x16_bf16 v[96:111], v[160:163], v[184:187], v[96:111]
  ds_read_b64_tr_b16 v[144:145], v12 offset:0
  ds_read_b64_tr_b16 v[146:147], v12 offset:1024
  buffer_load_dwordx4 v6, s[28:31], s54 offen lds
  v_mfma_f32_32x32x16_bf16 v[32:47], v[200:203], v[160:163], v[32:47]
  ds_read_b64_tr_b16 v[152:153], v13 offset:0
  buffer_load_dwordx4 v7, s[28:31], s54 offen offset:1024 lds
  s_add_u32 s53, s53, 1
  s_and_b32 s53, s53, 31
  s_mul_i32 s54, s53, 196608
  v_mfma_f32_32x32x16_bf16 v[80:95], v[168:171], v[176:179], v[80:95]
  ds_read_b64_tr_b16 v[154:155], v13 offset:1024
  ds_read_b64_tr_b16 v[192:193], v14 offset:0
  s_add_u32 m0, s22, 12288
  v_mfma_f32_32x32x16_bf16 v[112:127], v[168:171], v[184:187], v[112:127]
  ds_read_b64_tr_b16 v[194:195], v14 offset:512
  buffer_load_dwordx4 v16, s[28:31], s23 offen lds
  s_add_u32 s23, s23, 196608
  s_cmp_eq_u32 s23, 6291456
	s_nop 0
  s_cselect_b32 s23, 0, s23
  v_mfma_f32_32x32x16_bf16 v[48:63], v[200:203], v[168:171], v[48:63]
  ds_read_b128 v[132:135], v9 offset:16384
  ds_read_b128 v[140:143], v9 offset:20480
  v_mfma_f32_32x32x16_bf16 v[64:79], v[164:167], v[180:183], v[64:79]
  ds_read_b64_tr_b16 v[148:149], v12 offset:4096
  ds_read_b64_tr_b16 v[150:151], v12 offset:5120
	s_nop 0
  s_add_u32 m0, s50, 0
  v_mfma_f32_32x32x16_bf16 v[96:111], v[164:167], v[188:191], v[96:111]
  ds_read_b64_tr_b16 v[156:157], v13 offset:4096
  buffer_load_dwordx4 v2, s[24:27], s52 offen lds
  v_mfma_f32_32x32x16_bf16 v[32:47], v[204:207], v[164:167], v[32:47]
  ds_read_b64_tr_b16 v[158:159], v13 offset:5120
  ds_read_b64_tr_b16 v[196:197], v14 offset:2048
  buffer_load_dwordx4 v3, s[24:27], s52 offen offset:1024 lds
  v_mfma_f32_32x32x16_bf16 v[80:95], v[172:175], v[180:183], v[80:95]
  ds_read_b64_tr_b16 v[198:199], v14 offset:2560
  buffer_load_dwordx4 v4, s[24:27], s52 offen offset:2048 lds
  v_mfma_f32_32x32x16_bf16 v[112:127], v[172:175], v[188:191], v[112:127]
  buffer_load_dwordx4 v5, s[24:27], s52 offen offset:3072 lds
  s_add_u32 s52, s52, 128
  s_and_b32 s52, s52, 0x7ff
  v_mfma_f32_32x32x16_bf16 v[48:63], v[204:207], v[172:175], v[48:63]
  s_waitcnt lgkmcnt(0)
  s_barrier
  v_mfma_f32_32x32x16_bf16 v[64:79], v[128:131], v[144:147], v[64:79]
  ds_read_b128 v[160:163], v10 offset:16384
  ds_read_b128 v[168:171], v10 offset:20480
	s_nop 0
  s_add_u32 m0, s22, 0
  v_mfma_f32_32x32x16_bf16 v[96:111], v[128:131], v[152:155], v[96:111]
  ds_read_b64_tr_b16 v[176:177], v12 offset:8192
  ds_read_b64_tr_b16 v[178:179], v12 offset:9216
  v_mfma_f32_32x32x16_bf16 v[32:47], v[192:195], v[128:131], v[32:47]
  ds_read_b64_tr_b16 v[184:185], v13 offset:8192
  v_mfma_f32_32x32x16_bf16 v[80:95], v[136:139], v[144:147], v[80:95]
  ds_read_b64_tr_b16 v[186:187], v13 offset:9216
  ds_read_b64_tr_b16 v[200:201], v14 offset:4096
  v_mfma_f32_32x32x16_bf16 v[112:127], v[136:139], v[152:155], v[112:127]
  ds_read_b64_tr_b16 v[202:203], v14 offset:4608
  v_mfma_f32_32x32x16_bf16 v[48:63], v[192:195], v[136:139], v[48:63]
  ds_read_b128 v[164:167], v11 offset:16384
  ds_read_b128 v[172:175], v11 offset:20480
  v_mfma_f32_32x32x16_bf16 v[64:79], v[132:135], v[148:151], v[64:79]
  ds_read_b64_tr_b16 v[180:181], v12 offset:12288
  ds_read_b64_tr_b16 v[182:183], v12 offset:13312
  buffer_load_dwordx4 v16, s[28:31], s23 offen lds
  s_add_u32 s23, s23, 196608
  s_cmp_eq_u32 s23, 6291456
	s_nop 0
  s_cselect_b32 s23, 0, s23
  v_mfma_f32_32x32x16_bf16 v[96:111], v[132:135], v[156:159], v[96:111]
  ds_read_b64_tr_b16 v[188:189], v13 offset:12288
  v_mfma_f32_32x32x16_bf16 v[32:47], v[196:199], v[132:135], v[32:47]
  ds_read_b64_tr_b16 v[190:191], v13 offset:13312
  ds_read_b64_tr_b16 v[204:205], v14 offset:6144
  v_mfma_f32_32x32x16_bf16 v[80:95], v[140:143], v[148:151], v[80:95]
  ds_read_b64_tr_b16 v[206:207], v14 offset:6656
  v_mfma_f32_32x32x16_bf16 v[112:127], v[140:143], v[156:159], v[112:127]
  v_mfma_f32_32x32x16_bf16 v[48:63], v[196:199], v[140:143], v[48:63]
  s_waitcnt vmcnt(1)
  s_waitcnt lgkmcnt(0)
	s_nop 0
  s_barrier
  v_mfma_f32_32x32x16_bf16 v[64:79], v[160:163], v[176:179], v[64:79]
  ds_read_b128 v[128:131], v8 offset:0
  ds_read_b128 v[136:139], v8 offset:4096
  s_add_u32 m0, s22, 4096
  v_mfma_f32_32x32x16_bf16 v[96:111], v[160:163], v[184:187], v[96:111]
  ds_read_b64_tr_b16 v[144:145], v12 offset:16384
  ds_read_b64_tr_b16 v[146:147], v12 offset:17408
  buffer_load_dwordx4 v16, s[28:31], s23 offen lds
  s_add_u32 s23, s23, 196608
  s_cmp_eq_u32 s23, 6291456
	s_nop 0
  s_cselect_b32 s23, 0, s23
  v_mfma_f32_32x32x16_bf16 v[32:47], v[200:203], v[160:163], v[32:47]
  ds_read_b64_tr_b16 v[152:153], v13 offset:16384
  v_mfma_f32_32x32x16_bf16 v[80:95], v[168:171], v[176:179], v[80:95]
  ds_read_b64_tr_b16 v[154:155], v13 offset:17408
  ds_read_b64_tr_b16 v[192:193], v14 offset:8192
  s_add_u32 m0, s50, 16384
  v_mfma_f32_32x32x16_bf16 v[112:127], v[168:171], v[184:187], v[112:127]
  ds_read_b64_tr_b16 v[194:195], v14 offset:8704
  v_mfma_f32_32x32x16_bf16 v[48:63], v[200:203], v[168:171], v[48:63]
  ds_read_b128 v[132:135], v9 offset:0
  ds_read_b128 v[140:143], v9 offset:4096
  buffer_load_dwordx4 v2, s[24:27], s52 offen lds
  v_mfma_f32_32x32x16_bf16 v[64:79], v[164:167], v[180:183], v[64:79]
  ds_read_b64_tr_b16 v[148:149], v12 offset:20480
  ds_read_b64_tr_b16 v[150:151], v12 offset:21504
  buffer_load_dwordx4 v3, s[24:27], s52 offen offset:1024 lds
  v_mfma_f32_32x32x16_bf16 v[96:111], v[164:167], v[188:191], v[96:111]
  ds_read_b64_tr_b16 v[156:157], v13 offset:20480
  v_mfma_f32_32x32x16_bf16 v[32:47], v[204:207], v[164:167], v[32:47]
  ds_read_b64_tr_b16 v[158:159], v13 offset:21504
  ds_read_b64_tr_b16 v[196:197], v14 offset:10240
  buffer_load_dwordx4 v4, s[24:27], s52 offen offset:2048 lds
  v_mfma_f32_32x32x16_bf16 v[80:95], v[172:175], v[180:183], v[80:95]
  ds_read_b64_tr_b16 v[198:199], v14 offset:10752
  v_mfma_f32_32x32x16_bf16 v[112:127], v[172:175], v[188:191], v[112:127]
  buffer_load_dwordx4 v5, s[24:27], s52 offen offset:3072 lds
  s_add_u32 s52, s52, 128
  s_and_b32 s52, s52, 0x7ff
  v_mfma_f32_32x32x16_bf16 v[48:63], v[204:207], v[172:175], v[48:63]
  s_waitcnt lgkmcnt(0)
  s_barrier
  v_mfma_f32_32x32x16_bf16 v[64:79], v[128:131], v[144:147], v[64:79]
  ds_read_b128 v[160:163], v10 offset:0
  ds_read_b128 v[168:171], v10 offset:4096
  s_add_u32 m0, s22, 8192
  v_mfma_f32_32x32x16_bf16 v[96:111], v[128:131], v[152:155], v[96:111]
  ds_read_b64_tr_b16 v[176:177], v12 offset:24576
  ds_read_b64_tr_b16 v[178:179], v12 offset:25600
  v_mfma_f32_32x32x16_bf16 v[32:47], v[192:195], v[128:131], v[32:47]
  ds_read_b64_tr_b16 v[184:185], v13 offset:24576
  v_mfma_f32_32x32x16_bf16 v[80:95], v[136:139], v[144:147], v[80:95]
  ds_read_b64_tr_b16 v[186:187], v13 offset:25600
  ds_read_b64_tr_b16 v[200:201], v14 offset:12288
  v_mfma_f32_32x32x16_bf16 v[112:127], v[136:139], v[152:155], v[112:127]
  ds_read_b64_tr_b16 v[202:203], v14 offset:12800
  v_mfma_f32_32x32x16_bf16 v[48:63], v[192:195], v[136:139], v[48:63]
  ds_read_b128 v[164:167], v11 offset:0
  ds_read_b128 v[172:175], v11 offset:4096
  v_mfma_f32_32x32x16_bf16 v[64:79], v[132:135], v[148:151], v[64:79]
  ds_read_b64_tr_b16 v[180:181], v12 offset:28672
  ds_read_b64_tr_b16 v[182:183], v12 offset:29696
  buffer_load_dwordx4 v16, s[28:31], s23 offen lds
  s_add_u32 s23, s23, 196608
  s_cmp_eq_u32 s23, 6291456
	s_nop 0
  s_cselect_b32 s23, 0, s23
  v_mfma_f32_32x32x16_bf16 v[96:111], v[132:135], v[156:159], v[96:111]
  ds_read_b64_tr_b16 v[188:189], v13 offset:28672
  v_mfma_f32_32x32x16_bf16 v[32:47], v[196:199], v[132:135], v[32:47]
  ds_read_b64_tr_b16 v[190:191], v13 offset:29696
  ds_read_b64_tr_b16 v[204:205], v14 offset:14336
  v_mfma_f32_32x32x16_bf16 v[80:95], v[140:143], v[148:151], v[80:95]
  ds_read_b64_tr_b16 v[206:207], v14 offset:14848
  v_mfma_f32_32x32x16_bf16 v[112:127], v[140:143], v[156:159], v[112:127]
  v_mfma_f32_32x32x16_bf16 v[48:63], v[196:199], v[140:143], v[48:63]
  s_waitcnt lgkmcnt(0)
  s_barrier
  v_mfma_f32_32x32x16_bf16 v[64:79], v[160:163], v[176:179], v[64:79]
  s_add_u32 m0, s22, 12288
  v_mfma_f32_32x32x16_bf16 v[96:111], v[160:163], v[184:187], v[96:111]
  buffer_load_dwordx4 v16, s[28:31], s23 offen lds
  s_add_u32 s23, s23, 196608
  s_cmp_eq_u32 s23, 6291456
  s_cselect_b32 s23, 0, s23
  v_mfma_f32_32x32x16_bf16 v[32:47], v[200:203], v[160:163], v[32:47]
  v_mfma_f32_32x32x16_bf16 v[80:95], v[168:171], v[176:179], v[80:95]
  s_add_u32 m0, s50, 0
  v_mfma_f32_32x32x16_bf16 v[112:127], v[168:171], v[184:187], v[112:127]
  v_mfma_f32_32x32x16_bf16 v[48:63], v[200:203], v[168:171], v[48:63]
  buffer_load_dwordx4 v2, s[24:27], s52 offen lds
  v_mfma_f32_32x32x16_bf16 v[64:79], v[164:167], v[180:183], v[64:79]
  buffer_load_dwordx4 v3, s[24:27], s52 offen offset:1024 lds
  v_mfma_f32_32x32x16_bf16 v[96:111], v[164:167], v[188:191], v[96:111]
  v_mfma_f32_32x32x16_bf16 v[32:47], v[204:207], v[164:167], v[32:47]
  buffer_load_dwordx4 v4, s[24:27], s52 offen offset:2048 lds
  v_mfma_f32_32x32x16_bf16 v[80:95], v[172:175], v[180:183], v[80:95]
  v_mfma_f32_32x32x16_bf16 v[112:127], v[172:175], v[188:191], v[112:127]
  buffer_load_dwordx4 v5, s[24:27], s52 offen offset:3072 lds
  s_add_u32 s52, s52, 128
  s_and_b32 s52, s52, 0x7ff
  v_mfma_f32_32x32x16_bf16 v[48:63], v[204:207], v[172:175], v[48:63]
  v_mov_b32 v192, 0x3f803f80
  v_mov_b32 v193, 0x3f803f80
  v_mov_b32 v194, 0x3f803f80
  v_mov_b32 v195, 0x3f803f80
  v_cvt_pk_bf16_f32 v144, v96, v97
  v_cvt_pk_bf16_f32 v145, v98, v99
  v_cvt_pk_bf16_f32 v146, v100, v101
  v_cvt_pk_bf16_f32 v147, v102, v103
  v_cvt_pk_bf16_f32 v148, v104, v105
  v_cvt_pk_bf16_f32 v149, v106, v107
  v_cvt_pk_bf16_f32 v150, v108, v109
  v_cvt_pk_bf16_f32 v151, v110, v111
  v_cvt_pk_bf16_f32 v152, v112, v113
  v_cvt_pk_bf16_f32 v153, v114, v115
  v_cvt_pk_bf16_f32 v154, v116, v117
  v_cvt_pk_bf16_f32 v155, v118, v119
  v_cvt_pk_bf16_f32 v156, v120, v121
  v_cvt_pk_bf16_f32 v157, v122, v123
  v_cvt_pk_bf16_f32 v158, v124, v125
  v_cvt_pk_bf16_f32 v159, v126, v127
  v_mul_f32 v196, 0x3fb8aa3b, v64
  v_mul_f32 v197, 0x3fb8aa3b, v65
  v_mul_f32 v198, 0x3fb8aa3b, v66
  v_mul_f32 v199, 0x3fb8aa3b, v67
  v_exp_f32_e64 v196, v196 clamp
  v_exp_f32_e64 v197, v197 clamp
  v_exp_f32_e64 v198, v198 clamp
  v_exp_f32_e64 v199, v199 clamp
  v_max_f32 v64, 0, v64
  v_max_f32 v65, 0, v65
  v_max_f32 v66, 0, v66
  v_max_f32 v67, 0, v67
  v_add_f32 v64, 0x358637bd, v64
  v_add_f32 v65, 0x358637bd, v65
  v_add_f32 v66, 0x358637bd, v66
  v_add_f32 v67, 0x358637bd, v67
  v_add_f32 v64, v64, v196
  v_add_f32 v65, v65, v197
  v_add_f32 v66, v66, v198
  v_add_f32 v67, v67, v199
  v_mul_f32 v196, 0x3fb8aa3b, v68
  v_mul_f32 v197, 0x3fb8aa3b, v69
  v_mul_f32 v198, 0x3fb8aa3b, v70
  v_mul_f32 v199, 0x3fb8aa3b, v71
  v_exp_f32_e64 v196, v196 clamp
  v_exp_f32_e64 v197, v197 clamp
  v_exp_f32_e64 v198, v198 clamp
  v_exp_f32_e64 v199, v199 clamp
  v_max_f32 v68, 0, v68
  v_max_f32 v69, 0, v69
  v_max_f32 v70, 0, v70
  v_max_f32 v71, 0, v71
  v_add_f32 v68, 0x358637bd, v68
  v_add_f32 v69, 0x358637bd, v69
  v_add_f32 v70, 0x358637bd, v70
  v_add_f32 v71, 0x358637bd, v71
  v_add_f32 v68, v68, v196
  v_add_f32 v69, v69, v197
  v_add_f32 v70, v70, v198
  v_add_f32 v71, v71, v199
  v_mul_f32 v196, 0x3fb8aa3b, v72
  v_mul_f32 v197, 0x3fb8aa3b, v73
  v_mul_f32 v198, 0x3fb8aa3b, v74
  v_mul_f32 v199, 0x3fb8aa3b, v75
  v_exp_f32_e64 v196, v196 clamp
  v_exp_f32_e64 v197, v197 clamp
  v_exp_f32_e64 v198, v198 clamp
  v_exp_f32_e64 v199, v199 clamp
  v_max_f32 v72, 0, v72
  v_max_f32 v73, 0, v73
  v_max_f32 v74, 0, v74
  v_max_f32 v75, 0, v75
  v_add_f32 v72, 0x358637bd, v72
  v_add_f32 v73, 0x358637bd, v73
  v_add_f32 v74, 0x358637bd, v74
  v_add_f32 v75, 0x358637bd, v75
  v_add_f32 v72, v72, v196
  v_add_f32 v73, v73, v197
  v_add_f32 v74, v74, v198
  v_add_f32 v75, v75, v199
  v_mul_f32 v196, 0x3fb8aa3b, v76
  v_mul_f32 v197, 0x3fb8aa3b, v77
  v_mul_f32 v198, 0x3fb8aa3b, v78
  v_mul_f32 v199, 0x3fb8aa3b, v79
  v_exp_f32_e64 v196, v196 clamp
  v_exp_f32_e64 v197, v197 clamp
  v_exp_f32_e64 v198, v198 clamp
  v_exp_f32_e64 v199, v199 clamp
  v_max_f32 v76, 0, v76
  v_max_f32 v77, 0, v77
  v_max_f32 v78, 0, v78
  v_max_f32 v79, 0, v79
  v_add_f32 v76, 0x358637bd, v76
  v_add_f32 v77, 0x358637bd, v77
  v_add_f32 v78, 0x358637bd, v78
  v_add_f32 v79, 0x358637bd, v79
  v_add_f32 v76, v76, v196
  v_add_f32 v77, v77, v197
  v_add_f32 v78, v78, v198
  v_add_f32 v79, v79, v199
  v_cvt_pk_bf16_f32 v128, v64, v65
  v_cvt_pk_bf16_f32 v129, v66, v67
  v_cvt_pk_bf16_f32 v130, v68, v69
  v_cvt_pk_bf16_f32 v131, v70, v71
  v_cvt_pk_bf16_f32 v132, v72, v73
  v_cvt_pk_bf16_f32 v133, v74, v75
  v_cvt_pk_bf16_f32 v134, v76, v77
  v_cvt_pk_bf16_f32 v135, v78, v79
  v_mfma_f32_32x32x16_bf16 v[160:175], v[128:131], v[144:147], 0
  v_mfma_f32_32x32x16_bf16 v[176:191], v[192:195], v[128:131], 0
  v_mfma_f32_32x32x16_bf16 v[160:175], v[132:135], v[148:151], v[160:175]
  v_mfma_f32_32x32x16_bf16 v[176:191], v[192:195], v[132:135], v[176:191]
  v_mul_f32 v196, 0x3fb8aa3b, v80
  v_mul_f32 v197, 0x3fb8aa3b, v81
  v_mul_f32 v198, 0x3fb8aa3b, v82
  v_mul_f32 v199, 0x3fb8aa3b, v83
  v_exp_f32_e64 v196, v196 clamp
  v_exp_f32_e64 v197, v197 clamp
  v_exp_f32_e64 v198, v198 clamp
  v_exp_f32_e64 v199, v199 clamp
  v_max_f32 v80, 0, v80
  v_max_f32 v81, 0, v81
  v_max_f32 v82, 0, v82
  v_max_f32 v83, 0, v83
  v_add_f32 v80, 0x358637bd, v80
  v_add_f32 v81, 0x358637bd, v81
  v_add_f32 v82, 0x358637bd, v82
  v_add_f32 v83, 0x358637bd, v83
  v_add_f32 v80, v80, v196
  v_add_f32 v81, v81, v197
  v_add_f32 v82, v82, v198
  v_add_f32 v83, v83, v199
  v_mul_f32 v196, 0x3fb8aa3b, v84
  v_mul_f32 v197, 0x3fb8aa3b, v85
  v_mul_f32 v198, 0x3fb8aa3b, v86
  v_mul_f32 v199, 0x3fb8aa3b, v87
  v_exp_f32_e64 v196, v196 clamp
  v_exp_f32_e64 v197, v197 clamp
  v_exp_f32_e64 v198, v198 clamp
  v_exp_f32_e64 v199, v199 clamp
  v_max_f32 v84, 0, v84
  v_max_f32 v85, 0, v85
  v_max_f32 v86, 0, v86
  v_max_f32 v87, 0, v87
  v_add_f32 v84, 0x358637bd, v84
  v_add_f32 v85, 0x358637bd, v85
  v_add_f32 v86, 0x358637bd, v86
  v_add_f32 v87, 0x358637bd, v87
  v_add_f32 v84, v84, v196
  v_add_f32 v85, v85, v197
  v_add_f32 v86, v86, v198
  v_add_f32 v87, v87, v199
  v_mul_f32 v196, 0x3fb8aa3b, v88
  v_mul_f32 v197, 0x3fb8aa3b, v89
  v_mul_f32 v198, 0x3fb8aa3b, v90
  v_mul_f32 v199, 0x3fb8aa3b, v91
  v_exp_f32_e64 v196, v196 clamp
  v_exp_f32_e64 v197, v197 clamp
  v_exp_f32_e64 v198, v198 clamp
  v_exp_f32_e64 v199, v199 clamp
  v_max_f32 v88, 0, v88
  v_max_f32 v89, 0, v89
  v_max_f32 v90, 0, v90
  v_max_f32 v91, 0, v91
  v_add_f32 v88, 0x358637bd, v88
  v_add_f32 v89, 0x358637bd, v89
  v_add_f32 v90, 0x358637bd, v90
  v_add_f32 v91, 0x358637bd, v91
  v_add_f32 v88, v88, v196
  v_add_f32 v89, v89, v197
  v_add_f32 v90, v90, v198
  v_add_f32 v91, v91, v199
  v_mul_f32 v196, 0x3fb8aa3b, v92
  v_mul_f32 v197, 0x3fb8aa3b, v93
  v_mul_f32 v198, 0x3fb8aa3b, v94
  v_mul_f32 v199, 0x3fb8aa3b, v95
  v_exp_f32_e64 v196, v196 clamp
  v_exp_f32_e64 v197, v197 clamp
  v_exp_f32_e64 v198, v198 clamp
  v_exp_f32_e64 v199, v199 clamp
  v_max_f32 v92, 0, v92
  v_max_f32 v93, 0, v93
  v_max_f32 v94, 0, v94
  v_max_f32 v95, 0, v95
  v_add_f32 v92, 0x358637bd, v92
  v_add_f32 v93, 0x358637bd, v93
  v_add_f32 v94, 0x358637bd, v94
  v_add_f32 v95, 0x358637bd, v95
  v_add_f32 v92, v92, v196
  v_add_f32 v93, v93, v197
  v_add_f32 v94, v94, v198
  v_add_f32 v95, v95, v199
  v_cvt_pk_bf16_f32 v136, v80, v81
  v_cvt_pk_bf16_f32 v137, v82, v83
  v_cvt_pk_bf16_f32 v138, v84, v85
  v_cvt_pk_bf16_f32 v139, v86, v87
  v_cvt_pk_bf16_f32 v140, v88, v89
  v_cvt_pk_bf16_f32 v141, v90, v91
  v_cvt_pk_bf16_f32 v142, v92, v93
  v_cvt_pk_bf16_f32 v143, v94, v95
  v_mfma_f32_32x32x16_bf16 v[160:175], v[136:139], v[152:155], v[160:175]
  v_mfma_f32_32x32x16_bf16 v[176:191], v[192:195], v[136:139], v[176:191]
  v_mfma_f32_32x32x16_bf16 v[160:175], v[140:143], v[156:159], v[160:175]
  v_mfma_f32_32x32x16_bf16 v[176:191], v[192:195], v[140:143], v[176:191]
  s_lshl_b32 s46, s48, 1
  s_add_u32 s47, s46, s49
  s_lshl_b32 s47, s47, 11
  s_add_u32 s47, s47, 73728
  v_add_u32 v20, s47, v15
  s_xor_b32 s47, s47, 2048
  v_add_u32 v21, s47, v15
  s_lshl_b32 s46, s42, 1
  s_add_u32 s56, s46, s48
  s_lshl_b32 s47, s56, 4
  s_add_u32 s47, s47, s41
  s_lshl_b32 s47, s47, 11
  s_lshl_b32 s57, s49, 10
  s_add_u32 s47, s47, s57
  s_lshl_b32 s46, s56, 5
  s_lshl_b32 s57, s41, 1
  s_add_u32 s46, s46, s57
  s_add_u32 s46, s46, s49
  s_lshl_b32 s46, s46, 7
  v_and_b32 v22, 31, v1
  s_lshl_b32 s57, s49, 4
  v_xor_b32 v22, s57, v22
  v_lshlrev_b32_e64 v22, 2, v22
  ds_write_b128 v20, v[168:171]
  ds_write_b128 v20, v[172:175] offset:1024
  buffer_store_dword v176, v22, s[36:39], s46 offen sc1
  s_waitcnt lgkmcnt(0)
  s_barrier
  ds_read_b128 v[196:199], v21
  ds_read_b128 v[200:203], v21 offset:1024
  s_waitcnt lgkmcnt(1)
  v_add_f32 v160, v160, v196
  v_add_f32 v161, v161, v197
  v_add_f32 v162, v162, v198
  v_add_f32 v163, v163, v199
  s_waitcnt lgkmcnt(0)
  v_add_f32 v164, v164, v200
  v_add_f32 v165, v165, v201
  v_add_f32 v166, v166, v202
  v_add_f32 v167, v167, v203
  v_cvt_pk_bf16_f32 v204, v160, v161
  v_cvt_pk_bf16_f32 v205, v162, v163
  v_cvt_pk_bf16_f32 v206, v164, v165
  v_cvt_pk_bf16_f32 v207, v166, v167
  buffer_store_dwordx4 v[204:207], v15, s[32:35], s47 offen sc1
  v_mov_b32 v27, 0
  v_mov_b32 v28, 1
  buffer_load_dword v26, v27, s[64:67], 0 offen sc1
  v_and_b32 v18, 31, v1
  v_lshlrev_b32 v18, 2, v18
  v_lshrrev_b32 v20, 5, v1
  v_lshlrev_b32 v20, 10, v20
  v_add_u32 v18, v18, v20
  v_and_b32 v20, 31, v1
  v_lshrrev_b32 v21, 5, v1
  v_lshlrev_b32 v21, 2, v21
  v_sub_u32_e64 v20, v20, v21
  v_mov_b32 v22, 0x3f80
  v_mov_b32 v23, 0x3f800000
  v_cmp_eq_u32 vcc, 0, v20
  s_nop 1
  v_cndmask_b32 v208, 0, v22, vcc
  v_cmp_eq_u32 vcc, 1, v20
  s_nop 1
  v_cndmask_b32 v208, v208, v23, vcc
  v_cmp_eq_u32 vcc, 2, v20
  s_nop 1
  v_cndmask_b32 v209, 0, v22, vcc
  v_cmp_eq_u32 vcc, 3, v20
  s_nop 1
  v_cndmask_b32 v209, v209, v23, vcc
  v_cmp_eq_u32 vcc, 8, v20
  s_nop 1
  v_cndmask_b32 v210, 0, v22, vcc
  v_cmp_eq_u32 vcc, 9, v20
  s_nop 1
  v_cndmask_b32 v210, v210, v23, vcc
  v_cmp_eq_u32 vcc, 10, v20
  s_nop 1
  v_cndmask_b32 v211, 0, v22, vcc
  v_cmp_eq_u32 vcc, 11, v20
  s_nop 1
  v_cndmask_b32 v211, v211, v23, vcc
  v_cmp_eq_u32 vcc, 16, v20
  s_nop 1
  v_cndmask_b32 v212, 0, v22, vcc
  v_cmp_eq_u32 vcc, 17, v20
  s_nop 1
  v_cndmask_b32 v212, v212, v23, vcc
  v_cmp_eq_u32 vcc, 18, v20
  s_nop 1
  v_cndmask_b32 v213, 0, v22, vcc
  v_cmp_eq_u32 vcc, 19, v20
  s_nop 1
  v_cndmask_b32 v213, v213, v23, vcc
  v_cmp_eq_u32 vcc, 24, v20
  s_nop 1
  v_cndmask_b32 v214, 0, v22, vcc
  v_cmp_eq_u32 vcc, 25, v20
  s_nop 1
  v_cndmask_b32 v214, v214, v23, vcc
  v_cmp_eq_u32 vcc, 26, v20
  s_nop 1
  v_cndmask_b32 v215, 0, v22, vcc
  v_cmp_eq_u32 vcc, 27, v20
  s_nop 1
  v_cndmask_b32_e64 v215, v215, v23, vcc
  v_mov_b32 v216, 0x3f803f80
  v_mov_b32 v217, 0x3f803f80
  v_mov_b32 v218, 0x3f803f80
  v_mov_b32 v219, 0x3f803f80
  v_and_b32_e64 v19, 15, v1
  v_lshlrev_b32 v19, 2, v19
  s_lshl_b32 s58, s42, 8
  s_lshl_b32 s46, s41, 2
  s_add_u32 s69, s58, s46
  s_mov_b32 s12, s8
  s_mov_b32 s13, s9
  s_mov_b32 s14, 2097152
  s_mov_b32 s15, 0x00020000
  s_lshl_b32 s55, s45, 7
  v_lshrrev_b32 v20, 3, v1
  s_lshl_b32 s46, s40, 4
  v_add_u32 v20, s46, v20
  s_mov_b32 s47, 2048
  v_mul_lo_u32 v20, v20, s47
  v_bfe_u32 v21, v1, 2, 1
  v_bfe_u32 v22, v1, 4, 1
  v_xor_b32 v21, v21, v22
  v_lshlrev_b32 v21, 6, v21
  v_and_b32 v22, 3, v1
  v_lshlrev_b32 v22, 4, v22
  v_add3_u32 v20, v20, v21, v22
  v_add_u32 v30, s55, v20
  v_add_u32 v31, 15360, v30
  s_lshl_b32 s51, s40, 11
  s_mul_i32 s54, s3, 131072
  s_waitcnt vmcnt(9)
  s_barrier
  ds_read_b128 v[128:131], v8 offset:16384
  ds_read_b128 v[136:139], v8 offset:20480
  ds_read_b64_tr_b16 v[192:193], v14 offset:0
  ds_read_b64_tr_b16 v[194:195], v14 offset:512
  ds_read_b128 v[132:135], v9 offset:16384
  ds_read_b128 v[140:143], v9 offset:20480
  ds_read_b64_tr_b16 v[196:197], v14 offset:2048
  ds_read_b64_tr_b16 v[198:199], v14 offset:2560
  s_waitcnt lgkmcnt(0)
  s_barrier
  v_mfma_f32_32x32x16_bf16 v[32:47], v[192:195], v[128:131], v[32:47]
  ds_read_b128 v[160:163], v10 offset:16384
  ds_read_b128 v[168:171], v10 offset:20480
  ds_read_b64_tr_b16 v[200:201], v14 offset:4096
	s_nop 0
  s_add_u32 m0, s22, 0
  v_mfma_f32_32x32x16_bf16 v[48:63], v[192:195], v[136:139], v[48:63]
  ds_read_b64_tr_b16 v[202:203], v14 offset:4608
  ds_read_b128 v[164:167], v11 offset:16384
  ds_read_b128 v[172:175], v11 offset:20480
  v_mfma_f32_32x32x16_bf16 v[32:47], v[196:199], v[132:135], v[32:47]
  ds_read_b64_tr_b16 v[204:205], v14 offset:6144
  ds_read_b64_tr_b16 v[206:207], v14 offset:6656
  buffer_load_dwordx4 v16, s[28:31], s23 offen lds
  s_add_u32 s23, s23, 196608
  s_cmp_eq_u32 s23, 6291456
  s_cselect_b32 s23, 0, s23
  v_mfma_f32_32x32x16_bf16 v[48:63], v[196:199], v[140:143], v[48:63]
  s_waitcnt vmcnt(1)
  s_waitcnt lgkmcnt(0)
  s_barrier
  s_cmp_eq_u32 s40, 0
  s_cbranch_scc0 pw_1
  v_cmp_eq_u32 vcc, 0, v26
  s_cbranch_vccz ok_3
  s_mov_b32 s59, 40000
spin_4:
  s_sleep 1
  buffer_load_dword v26, v27, s[64:67], 0 offen sc1
  s_waitcnt vmcnt(0)
  v_cmp_eq_u32 vcc, 0, v26
  s_cbranch_vccz ok_3
  s_sub_u32 s59, s59, 1
  s_cmp_lg_u32 s59, 0
  s_cbranch_scc1 spin_4
ok_3:
  s_mov_b64 exec, 1
  buffer_store_dword v28, v27, s[60:63], s69 offen sc1
  s_mov_b64 exec, -1
  s_branch pe_2
pw_1:
  buffer_load_dword v26, v27, s[64:67], 0 offen
pe_2:
  v_mfma_f32_32x32x16_bf16 v[32:47], v[200:203], v[160:163], v[32:47]
  ds_read_b128 v[128:131], v8 offset:0
  ds_read_b128 v[136:139], v8 offset:4096
  ds_read_b64_tr_b16 v[192:193], v14 offset:8192
  s_add_u32 m0, s22, 4096
  s_nop 0
  buffer_load_dwordx4 v16, s[28:31], s23 offen lds
  s_add_u32 s23, s23, 196608
  s_cmp_eq_u32 s23, 6291456
  s_cselect_b32 s23, 0, s23
  v_mfma_f32_32x32x16_bf16 v[48:63], v[200:203], v[168:171], v[48:63]
  ds_read_b64_tr_b16 v[194:195], v14 offset:8704
  ds_read_b128 v[132:135], v9 offset:0
  ds_read_b128 v[140:143], v9 offset:4096
  s_add_u32 m0, s50, 16384
	s_nop 0
  s_nop 0
  buffer_load_dwordx4 v2, s[24:27], s52 offen lds
  v_mfma_f32_32x32x16_bf16 v[32:47], v[204:207], v[164:167], v[32:47]
  ds_read_b64_tr_b16 v[196:197], v14 offset:10240
  ds_read_b64_tr_b16 v[198:199], v14 offset:10752
  buffer_load_dwordx4 v3, s[24:27], s52 offen offset:1024 lds
  buffer_load_dwordx4 v4, s[24:27], s52 offen offset:2048 lds
  v_mfma_f32_32x32x16_bf16 v[48:63], v[204:207], v[172:175], v[48:63]
  buffer_load_dwordx4 v5, s[24:27], s52 offen offset:3072 lds
  s_add_u32 s52, s52, 128
  s_and_b32 s52, s52, 0x7ff
  s_waitcnt lgkmcnt(0)
  s_barrier
  v_mfma_f32_32x32x16_bf16 v[32:47], v[192:195], v[128:131], v[32:47]
  ds_read_b128 v[160:163], v10 offset:0
  ds_read_b128 v[168:171], v10 offset:4096
  ds_read_b64_tr_b16 v[200:201], v14 offset:12288
  s_add_u32 m0, s22, 8192
  s_nop 0
  buffer_load_dwordx4 v16, s[28:31], s23 offen lds
  s_add_u32 s23, s23, 196608
  s_cmp_eq_u32 s23, 6291456
  s_cselect_b32 s23, 0, s23
  v_mfma_f32_32x32x16_bf16 v[48:63], v[192:195], v[136:139], v[48:63]
  ds_read_b64_tr_b16 v[202:203], v14 offset:12800
  ds_read_b128 v[164:167], v11 offset:0
  ds_read_b128 v[172:175], v11 offset:4096
  s_add_u32 m0, s51, 49152
  v_mfma_f32_32x32x16_bf16 v[32:47], v[196:199], v[132:135], v[32:47]
  ds_read_b64_tr_b16 v[204:205], v14 offset:14336
  ds_read_b64_tr_b16 v[206:207], v14 offset:14848
  buffer_load_dwordx4 v30, s[12:15], s54 offen lds
  v_mfma_f32_32x32x16_bf16 v[48:63], v[196:199], v[140:143], v[48:63]
  buffer_load_dwordx4 v31, s[12:15], s54 offen offset:1024 lds
  s_add_u32 s54, s54, 131072
  s_cmp_eq_u32 s54, 2097152
  s_cselect_b32 s54, 0, s54
  s_waitcnt vmcnt(3)
  s_waitcnt lgkmcnt(0)
  s_barrier
  v_mfma_f32_32x32x16_bf16 v[32:47], v[200:203], v[160:163], v[32:47]
  ds_read_b128 v[128:131], v8 offset:16384
  ds_read_b128 v[136:139], v8 offset:20480
  ds_read_b64_tr_b16 v[192:193], v14 offset:0
  s_add_u32 m0, s22, 12288
	s_nop 0
  s_nop 0
  buffer_load_dwordx4 v16, s[28:31], s23 offen lds
  s_add_u32 s23, s23, 196608
  s_cmp_eq_u32 s23, 6291456
  s_cselect_b32 s23, 0, s23
  s_add_u32 m0, s50, 0
  v_mfma_f32_32x32x16_bf16 v[48:63], v[200:203], v[168:171], v[48:63]
  ds_read_b64_tr_b16 v[194:195], v14 offset:512
  ds_read_b128 v[132:135], v9 offset:16384
  ds_read_b128 v[140:143], v9 offset:20480
  buffer_load_dwordx4 v2, s[24:27], s52 offen lds
  buffer_load_dwordx4 v3, s[24:27], s52 offen offset:1024 lds
  v_mfma_f32_32x32x16_bf16 v[32:47], v[204:207], v[164:167], v[32:47]
  ds_read_b64_tr_b16 v[196:197], v14 offset:2048
  ds_read_b64_tr_b16 v[198:199], v14 offset:2560
  buffer_load_dwordx4 v4, s[24:27], s52 offen offset:2048 lds
  buffer_load_dwordx4 v5, s[24:27], s52 offen offset:3072 lds
  s_add_u32 s52, s52, 128
  s_and_b32 s52, s52, 0x7ff
  s_add_u32 m0, s51, 57344
  v_mfma_f32_32x32x16_bf16 v[48:63], v[204:207], v[172:175], v[48:63]
  buffer_load_dwordx4 v30, s[12:15], s54 offen lds
  buffer_load_dwordx4 v31, s[12:15], s54 offen offset:1024 lds
  s_add_u32 s54, s54, 131072
  s_cmp_eq_u32 s54, 2097152
  s_cselect_b32 s54, 0, s54
  s_waitcnt lgkmcnt(0)
	s_nop 0
  s_barrier
  v_mfma_f32_32x32x16_bf16 v[32:47], v[192:195], v[128:131], v[32:47]
  ds_read_b128 v[160:163], v10 offset:16384
  ds_read_b128 v[168:171], v10 offset:20480
  ds_read_b64_tr_b16 v[200:201], v14 offset:4096
  s_add_u32 m0, s51, 65536
  v_mfma_f32_32x32x16_bf16 v[48:63], v[192:195], v[136:139], v[48:63]
  ds_read_b64_tr_b16 v[202:203], v14 offset:4608
  ds_read_b128 v[164:167], v11 offset:16384
  ds_read_b128 v[172:175], v11 offset:20480
  buffer_load_dwordx4 v30, s[12:15], s54 offen lds
  v_mfma_f32_32x32x16_bf16 v[32:47], v[196:199], v[132:135], v[32:47]
  ds_read_b64_tr_b16 v[204:205], v14 offset:6144
  ds_read_b64_tr_b16 v[206:207], v14 offset:6656
  buffer_load_dwordx4 v31, s[12:15], s54 offen offset:1024 lds
  s_add_u32 s54, s54, 131072
  s_cmp_eq_u32 s54, 2097152
  s_cselect_b32 s54, 0, s54
  v_mfma_f32_32x32x16_bf16 v[48:63], v[196:199], v[140:143], v[48:63]
  s_waitcnt vmcnt(4)
  s_waitcnt lgkmcnt(0)
  s_barrier
  v_mfma_f32_32x32x16_bf16 v[32:47], v[200:203], v[160:163], v[32:47]
  ds_read_b128 v[128:131], v8 offset:0
  ds_read_b128 v[136:139], v8 offset:4096
  ds_read_b64_tr_b16 v[192:193], v14 offset:8192
  v_mfma_f32_32x32x16_bf16 v[48:63], v[200:203], v[168:171], v[48:63]
  ds_read_b64_tr_b16 v[194:195], v14 offset:8704
  ds_read_b128 v[132:135], v9 offset:0
  ds_read_b128 v[140:143], v9 offset:4096
  v_mfma_f32_32x32x16_bf16 v[32:47], v[204:207], v[164:167], v[32:47]
  ds_read_b64_tr_b16 v[196:197], v14 offset:10240
  ds_read_b64_tr_b16 v[198:199], v14 offset:10752
  v_mfma_f32_32x32x16_bf16 v[48:63], v[204:207], v[172:175], v[48:63]
  s_waitcnt lgkmcnt(0)
  s_barrier
  v_mfma_f32_32x32x16_bf16 v[32:47], v[192:195], v[128:131], v[32:47]
  ds_read_b128 v[160:163], v10 offset:0
  ds_read_b128 v[168:171], v10 offset:4096
  ds_read_b64_tr_b16 v[200:201], v14 offset:12288
  buffer_load_dword v26, v19, s[60:63], s58 offen sc1
  v_mfma_f32_32x32x16_bf16 v[48:63], v[192:195], v[136:139], v[48:63]
  ds_read_b64_tr_b16 v[202:203], v14 offset:12800
  ds_read_b128 v[164:167], v11 offset:0
  ds_read_b128 v[172:175], v11 offset:4096
  v_mfma_f32_32x32x16_bf16 v[32:47], v[196:199], v[132:135], v[32:47]
  ds_read_b64_tr_b16 v[204:205], v14 offset:14336
  ds_read_b64_tr_b16 v[206:207], v14 offset:14848
  v_mfma_f32_32x32x16_bf16 v[48:63], v[196:199], v[140:143], v[48:63]
  s_waitcnt lgkmcnt(0)
  s_barrier
  v_mfma_f32_32x32x16_bf16 v[32:47], v[200:203], v[160:163], v[32:47]
  v_mfma_f32_32x32x16_bf16 v[48:63], v[200:203], v[168:171], v[48:63]
  v_mfma_f32_32x32x16_bf16 v[32:47], v[204:207], v[164:167], v[32:47]
  v_mfma_f32_32x32x16_bf16 v[48:63], v[204:207], v[172:175], v[48:63]
  s_barrier
  s_waitcnt vmcnt(0)
  v_cmp_ne_u32 vcc, 1, v26
  s_cbranch_vccz ok_5
  s_mov_b32 s59, 40000
spin_6:
  s_sleep 1
  buffer_load_dword v26, v19, s[60:63], s58 offen sc1
  s_waitcnt vmcnt(0)
  v_cmp_ne_u32 vcc, 1, v26
  s_cbranch_vccz ok_5
  s_sub_u32 s59, s59, 1
  s_cmp_lg_u32 s59, 0
  s_cbranch_scc1 spin_6
ok_5:
  s_lshl_b32 s46, s56, 4
  s_lshl_b32 s47, s49, 3
  s_add_u32 s46, s46, s47
  s_lshl_b32 s57, s46, 11
  s_lshl_b32 s58, s56, 12
  buffer_load_dwordx4 v[64:67], v15, s[32:35], s57 offen sc1
  buffer_load_dwordx4 v[68:71], v15, s[32:35], s57 offen offset:1024 sc1
  buffer_load_dwordx4 v[72:75], v15, s[32:35], s57 offen offset:2048 sc1
  buffer_load_dwordx4 v[76:79], v15, s[32:35], s57 offen offset:3072 sc1
  s_add_u32 s57, s57, 4096
  buffer_load_dwordx4 v[80:83], v15, s[32:35], s57 offen sc1
  buffer_load_dwordx4 v[84:87], v15, s[32:35], s57 offen offset:1024 sc1
  buffer_load_dwordx4 v[88:91], v15, s[32:35], s57 offen offset:2048 sc1
  buffer_load_dwordx4 v[92:95], v15, s[32:35], s57 offen offset:3072 sc1
  s_add_u32 s57, s57, 4096
  buffer_load_dwordx4 v[96:99], v15, s[32:35], s57 offen sc1
  buffer_load_dwordx4 v[100:103], v15, s[32:35], s57 offen offset:1024 sc1
  buffer_load_dwordx4 v[104:107], v15, s[32:35], s57 offen offset:2048 sc1
  buffer_load_dwordx4 v[108:111], v15, s[32:35], s57 offen offset:3072 sc1
  s_add_u32 s57, s57, 4096
  buffer_load_dwordx4 v[112:115], v15, s[32:35], s57 offen sc1
  buffer_load_dwordx4 v[116:119], v15, s[32:35], s57 offen offset:1024 sc1
  buffer_load_dwordx4 v[120:123], v15, s[32:35], s57 offen offset:2048 sc1
  buffer_load_dwordx4 v[124:127], v15, s[32:35], s57 offen offset:3072 sc1
  buffer_load_dword v144, v18, s[36:39], s58 offen offset:0 sc1
  buffer_load_dword v145, v18, s[36:39], s58 offen offset:128 sc1
  buffer_load_dword v146, v18, s[36:39], s58 offen offset:256 sc1
  buffer_load_dword v147, v18, s[36:39], s58 offen offset:384 sc1
  buffer_load_dword v148, v18, s[36:39], s58 offen offset:512 sc1
  buffer_load_dword v149, v18, s[36:39], s58 offen offset:640 sc1
  buffer_load_dword v150, v18, s[36:39], s58 offen offset:768 sc1
  buffer_load_dword v151, v18, s[36:39], s58 offen offset:896 sc1
  buffer_load_dword v152, v18, s[36:39], s58 offen offset:2048 sc1
  buffer_load_dword v153, v18, s[36:39], s58 offen offset:2176 sc1
  buffer_load_dword v154, v18, s[36:39], s58 offen offset:2304 sc1
  buffer_load_dword v155, v18, s[36:39], s58 offen offset:2432 sc1
  buffer_load_dword v156, v18, s[36:39], s58 offen offset:2560 sc1
  buffer_load_dword v157, v18, s[36:39], s58 offen offset:2688 sc1
  buffer_load_dword v158, v18, s[36:39], s58 offen offset:2816 sc1
  buffer_load_dword v159, v18, s[36:39], s58 offen offset:2944 sc1
  s_add_u32 m0, s51, 0
  s_nop 0
  buffer_load_dwordx4 v30, s[12:15], s54 offen lds
  buffer_load_dwordx4 v31, s[12:15], s54 offen offset:1024 lds
  s_add_u32 s54, s54, 131072
  s_cmp_eq_u32 s54, 2097152
  s_cselect_b32 s54, 0, s54
  s_add_u32 m0, s51, 8192
  s_nop 0
  buffer_load_dwordx4 v30, s[12:15], s54 offen lds
  buffer_load_dwordx4 v31, s[12:15], s54 offen offset:1024 lds
  s_add_u32 s54, s54, 131072
  s_cmp_eq_u32 s54, 2097152
	s_nop 0
  s_cselect_b32 s54, 0, s54
  v_mul_f32 v196, 0x3fb8aa3b, v32
  v_mul_f32 v197, 0x3fb8aa3b, v33
  v_mul_f32 v198, 0x3fb8aa3b, v34
  v_mul_f32 v199, 0x3fb8aa3b, v35
  v_exp_f32_e64 v196, v196 clamp
  v_exp_f32_e64 v197, v197 clamp
  v_exp_f32_e64 v198, v198 clamp
  v_exp_f32_e64 v199, v199 clamp
  v_max_f32 v32, 0, v32
  v_max_f32 v33, 0, v33
  v_max_f32 v34, 0, v34
  v_max_f32 v35, 0, v35
  v_add_f32 v32, 0x358637bd, v32
  v_add_f32 v33, 0x358637bd, v33
  v_add_f32 v34, 0x358637bd, v34
  v_add_f32 v35, 0x358637bd, v35
  v_add_f32 v32, v32, v196
  v_add_f32 v33, v33, v197
  v_add_f32 v34, v34, v198
  v_add_f32 v35, v35, v199
  v_mul_f32 v196, 0x3fb8aa3b, v36
  v_mul_f32 v197, 0x3fb8aa3b, v37
  v_mul_f32 v198, 0x3fb8aa3b, v38
  v_mul_f32 v199, 0x3fb8aa3b, v39
  v_exp_f32_e64 v196, v196 clamp
  v_exp_f32_e64 v197, v197 clamp
  v_exp_f32_e64 v198, v198 clamp
  v_exp_f32_e64 v199, v199 clamp
  v_max_f32 v36, 0, v36
  v_max_f32 v37, 0, v37
  v_max_f32 v38, 0, v38
  v_max_f32 v39, 0, v39
  v_add_f32 v36, 0x358637bd, v36
  v_add_f32 v37, 0x358637bd, v37
  v_add_f32 v38, 0x358637bd, v38
  v_add_f32 v39, 0x358637bd, v39
  v_add_f32 v36, v36, v196
  v_add_f32 v37, v37, v197
  v_add_f32 v38, v38, v198
  v_add_f32 v39, v39, v199
  v_mul_f32 v196, 0x3fb8aa3b, v40
  v_mul_f32 v197, 0x3fb8aa3b, v41
  v_mul_f32 v198, 0x3fb8aa3b, v42
  v_mul_f32 v199, 0x3fb8aa3b, v43
  v_exp_f32_e64 v196, v196 clamp
  v_exp_f32_e64 v197, v197 clamp
  v_exp_f32_e64 v198, v198 clamp
  v_exp_f32_e64 v199, v199 clamp
  v_max_f32 v40, 0, v40
  v_max_f32 v41, 0, v41
  v_max_f32 v42, 0, v42
  v_max_f32 v43, 0, v43
  v_add_f32 v40, 0x358637bd, v40
  v_add_f32 v41, 0x358637bd, v41
  v_add_f32 v42, 0x358637bd, v42
  v_add_f32 v43, 0x358637bd, v43
  v_add_f32 v40, v40, v196
  v_add_f32 v41, v41, v197
  v_add_f32 v42, v42, v198
  v_add_f32 v43, v43, v199
  v_mul_f32 v196, 0x3fb8aa3b, v44
  v_mul_f32 v197, 0x3fb8aa3b, v45
  v_mul_f32 v198, 0x3fb8aa3b, v46
  v_mul_f32 v199, 0x3fb8aa3b, v47
  v_exp_f32_e64 v196, v196 clamp
  v_exp_f32_e64 v197, v197 clamp
  v_exp_f32_e64 v198, v198 clamp
  v_exp_f32_e64 v199, v199 clamp
  v_max_f32 v44, 0, v44
  v_max_f32 v45, 0, v45
  v_max_f32 v46, 0, v46
  v_max_f32 v47, 0, v47
  v_add_f32 v44, 0x358637bd, v44
  v_add_f32 v45, 0x358637bd, v45
  v_add_f32 v46, 0x358637bd, v46
  v_add_f32 v47, 0x358637bd, v47
  v_add_f32 v44, v44, v196
  v_add_f32 v45, v45, v197
  v_add_f32 v46, v46, v198
  v_add_f32 v47, v47, v199
  v_cvt_pk_bf16_f32 v128, v32, v33
  v_cvt_pk_bf16_f32 v129, v34, v35
  v_cvt_pk_bf16_f32 v130, v36, v37
  v_cvt_pk_bf16_f32 v131, v38, v39
  v_cvt_pk_bf16_f32 v132, v40, v41
  v_cvt_pk_bf16_f32 v133, v42, v43
  v_cvt_pk_bf16_f32 v134, v44, v45
  v_cvt_pk_bf16_f32 v135, v46, v47
  v_mul_f32 v196, 0x3fb8aa3b, v48
  v_mul_f32 v197, 0x3fb8aa3b, v49
  v_mul_f32 v198, 0x3fb8aa3b, v50
  v_mul_f32 v199, 0x3fb8aa3b, v51
  v_exp_f32_e64 v196, v196 clamp
  v_exp_f32_e64 v197, v197 clamp
  v_exp_f32_e64 v198, v198 clamp
  v_exp_f32_e64 v199, v199 clamp
  v_max_f32 v48, 0, v48
  v_max_f32 v49, 0, v49
  v_max_f32 v50, 0, v50
  v_max_f32 v51, 0, v51
  v_add_f32 v48, 0x358637bd, v48
  v_add_f32 v49, 0x358637bd, v49
  v_add_f32 v50, 0x358637bd, v50
  v_add_f32 v51, 0x358637bd, v51
  v_add_f32 v48, v48, v196
  v_add_f32 v49, v49, v197
  v_add_f32 v50, v50, v198
  v_add_f32 v51, v51, v199
  v_mul_f32 v196, 0x3fb8aa3b, v52
  v_mul_f32 v197, 0x3fb8aa3b, v53
  v_mul_f32 v198, 0x3fb8aa3b, v54
  v_mul_f32 v199, 0x3fb8aa3b, v55
  v_exp_f32_e64 v196, v196 clamp
  v_exp_f32_e64 v197, v197 clamp
  v_exp_f32_e64 v198, v198 clamp
  v_exp_f32_e64 v199, v199 clamp
  v_max_f32 v52, 0, v52
  v_max_f32 v53, 0, v53
  v_max_f32 v54, 0, v54
  v_max_f32 v55, 0, v55
  v_add_f32 v52, 0x358637bd, v52
  v_add_f32 v53, 0x358637bd, v53
  v_add_f32 v54, 0x358637bd, v54
  v_add_f32 v55, 0x358637bd, v55
  v_add_f32 v52, v52, v196
  v_add_f32 v53, v53, v197
  v_add_f32 v54, v54, v198
  v_add_f32 v55, v55, v199
  v_mul_f32 v196, 0x3fb8aa3b, v56
  v_mul_f32 v197, 0x3fb8aa3b, v57
  v_mul_f32 v198, 0x3fb8aa3b, v58
  v_mul_f32 v199, 0x3fb8aa3b, v59
  v_exp_f32_e64 v196, v196 clamp
  v_exp_f32_e64 v197, v197 clamp
  v_exp_f32_e64 v198, v198 clamp
  v_exp_f32_e64 v199, v199 clamp
  v_max_f32 v56, 0, v56
  v_max_f32 v57, 0, v57
  v_max_f32 v58, 0, v58
  v_max_f32 v59, 0, v59
  v_add_f32 v56, 0x358637bd, v56
  v_add_f32 v57, 0x358637bd, v57
  v_add_f32 v58, 0x358637bd, v58
  v_add_f32 v59, 0x358637bd, v59
  v_add_f32 v56, v56, v196
  v_add_f32 v57, v57, v197
  v_add_f32 v58, v58, v198
  v_add_f32 v59, v59, v199
  v_mul_f32 v196, 0x3fb8aa3b, v60
  v_mul_f32 v197, 0x3fb8aa3b, v61
  v_mul_f32 v198, 0x3fb8aa3b, v62
  v_mul_f32 v199, 0x3fb8aa3b, v63
  v_exp_f32_e64 v196, v196 clamp
  v_exp_f32_e64 v197, v197 clamp
  v_exp_f32_e64 v198, v198 clamp
  v_exp_f32_e64 v199, v199 clamp
  v_max_f32 v60, 0, v60
  v_max_f32 v61, 0, v61
  v_max_f32 v62, 0, v62
  v_max_f32 v63, 0, v63
  v_add_f32 v60, 0x358637bd, v60
  v_add_f32 v61, 0x358637bd, v61
  v_add_f32 v62, 0x358637bd, v62
  v_add_f32 v63, 0x358637bd, v63
  v_add_f32 v60, v60, v196
  v_add_f32 v61, v61, v197
  v_add_f32 v62, v62, v198
  v_add_f32 v63, v63, v199
  v_cvt_pk_bf16_f32 v136, v48, v49
  v_cvt_pk_bf16_f32 v137, v50, v51
  v_cvt_pk_bf16_f32 v138, v52, v53
  v_cvt_pk_bf16_f32 v139, v54, v55
  v_cvt_pk_bf16_f32 v140, v56, v57
  v_cvt_pk_bf16_f32 v141, v58, v59
  v_cvt_pk_bf16_f32 v142, v60, v61
  v_cvt_pk_bf16_f32 v143, v62, v63
  v_lshlrev_b32 v20, 4, v1
  s_lshl_b32 s46, s40, 12
  s_add_u32 s46, s46, 32768
  v_add_u32_e64 v21, s46, v20
  s_xor_b32 s46, s46, 8192
  v_add_u32 v29, s46, v20
  s_add_u32 s24, s20, 2097152
  s_addc_u32 s25, s21, 0
  s_mov_b32 s26, 4194304
  s_mov_b32 s27, 0x00020000
  s_waitcnt vmcnt(35)
  v_mfma_f32_32x32x16_bf16 v[176:191], v[208:211], v[64:67], 0
  s_waitcnt vmcnt(34)
  v_mfma_f32_32x32x16_bf16 v[176:191], v[212:215], v[68:71], v[176:191]
  s_waitcnt vmcnt(33)
  v_mfma_f32_32x32x16_bf16 v[176:191], v[208:211], v[72:75], v[176:191]
  s_waitcnt vmcnt(32)
  v_mfma_f32_32x32x16_bf16 v[176:191], v[212:215], v[76:79], v[176:191]
  s_waitcnt vmcnt(31)
  v_mfma_f32_32x32x16_bf16 v[176:191], v[208:211], v[80:83], v[176:191]
  s_waitcnt vmcnt(30)
  v_mfma_f32_32x32x16_bf16 v[176:191], v[212:215], v[84:87], v[176:191]
  s_waitcnt vmcnt(29)
  v_mfma_f32_32x32x16_bf16 v[176:191], v[208:211], v[88:91], v[176:191]
  s_waitcnt vmcnt(28)
  v_mfma_f32_32x32x16_bf16 v[176:191], v[212:215], v[92:95], v[176:191]
  s_waitcnt vmcnt(27)
  v_mfma_f32_32x32x16_bf16 v[176:191], v[208:211], v[96:99], v[176:191]
  s_waitcnt vmcnt(26)
  v_mfma_f32_32x32x16_bf16 v[176:191], v[212:215], v[100:103], v[176:191]
  s_waitcnt vmcnt(25)
  v_mfma_f32_32x32x16_bf16 v[176:191], v[208:211], v[104:107], v[176:191]
  s_waitcnt vmcnt(24)
  v_mfma_f32_32x32x16_bf16 v[176:191], v[212:215], v[108:111], v[176:191]
  s_waitcnt vmcnt(23)
  v_mfma_f32_32x32x16_bf16 v[176:191], v[208:211], v[112:115], v[176:191]
  s_waitcnt vmcnt(22)
  v_mfma_f32_32x32x16_bf16 v[176:191], v[212:215], v[116:119], v[176:191]
  s_waitcnt vmcnt(21)
  v_mfma_f32_32x32x16_bf16 v[176:191], v[208:211], v[120:123], v[176:191]
  s_waitcnt vmcnt(20)
  v_mfma_f32_32x32x16_bf16 v[176:191], v[212:215], v[124:127], v[176:191]
  s_waitcnt vmcnt(18)
  v_cvt_pk_bf16_f32 v144, v144, v145
  s_waitcnt vmcnt(16)
  v_cvt_pk_bf16_f32 v145, v146, v147
  s_waitcnt vmcnt(14)
  v_cvt_pk_bf16_f32 v146, v148, v149
  s_waitcnt vmcnt(12)
  v_cvt_pk_bf16_f32 v147, v150, v151
  s_waitcnt vmcnt(10)
  v_cvt_pk_bf16_f32 v148, v152, v153
  s_waitcnt vmcnt(8)
  v_cvt_pk_bf16_f32 v149, v154, v155
  s_waitcnt vmcnt(6)
  v_cvt_pk_bf16_f32 v150, v156, v157
  s_waitcnt vmcnt(4)
  v_cvt_pk_bf16_f32 v151, v158, v159
  v_mfma_f32_32x32x16_bf16 v[228:243], v[144:147], v[216:219], 0
	s_nop 0
  s_nop 0
  v_mfma_f32_32x32x16_bf16 v[228:243], v[148:151], v[216:219], v[228:243]
  ds_write_b128 v21, v[176:179] offset:0
  ds_write_b128 v21, v[180:183] offset:1024
  ds_write_b128 v21, v[184:187] offset:2048
  ds_write_b128 v21, v[188:191] offset:3072
  s_waitcnt lgkmcnt(0)
  s_barrier
  ds_read_b128 v[64:67], v29 offset:0
  ds_read_b128 v[68:71], v29 offset:1024
  ds_read_b128 v[72:75], v29 offset:2048
  ds_read_b128 v[76:79], v29 offset:3072
	s_nop 0
  s_nop 1
  v_cvt_pk_bf16_f32 v244, v228, v229
  v_cvt_pk_bf16_f32 v245, v230, v231
  v_cvt_pk_bf16_f32 v246, v232, v233
  v_cvt_pk_bf16_f32 v247, v234, v235
  v_cvt_pk_bf16_f32 v248, v236, v237
  v_cvt_pk_bf16_f32 v249, v238, v239
  v_cvt_pk_bf16_f32 v250, v240, v241
  v_cvt_pk_bf16_f32 v251, v242, v243
  v_mfma_f32_32x32x16_bf16 v[144:159], v[244:247], v[128:131], 0
	s_nop 0
  s_nop 0
  v_mfma_f32_32x32x16_bf16 v[144:159], v[248:251], v[132:135], v[144:159]
  v_mfma_f32_32x32x16_bf16 v[160:175], v[244:247], v[136:139], 0
  v_mfma_f32_32x32x16_bf16 v[160:175], v[248:251], v[140:143], v[160:175]
  s_lshl_b32 s46, s41, 2
  s_lshl_b32 s47, s49, 1
  s_add_u32 s46, s46, s47
  s_lshl_b32 s46, s46, 5
  s_add_u32 s46, s46, s56
  s_lshl_b32 s46, s46, 11
  s_nop 3
  v_add_f32 v144, 0x358637bd, v144
  v_rcp_f32 v144, v144
  v_add_f32 v160, 0x358637bd, v160
  v_rcp_f32 v160, v160
  s_waitcnt lgkmcnt(3)
  v_add_f32 v176, v176, v64
  v_add_f32 v177, v177, v65
  v_add_f32 v178, v178, v66
  v_add_f32 v179, v179, v67
  s_waitcnt lgkmcnt(2)
  v_add_f32 v180, v180, v68
  v_add_f32 v181, v181, v69
  v_add_f32 v182, v182, v70
  v_add_f32 v183, v183, v71
  s_waitcnt lgkmcnt(1)
  v_add_f32 v184, v184, v72
  v_add_f32 v185, v185, v73
  v_add_f32 v186, v186, v74
  v_add_f32 v187, v187, v75
  s_waitcnt lgkmcnt(0)
  v_add_f32 v188, v188, v76
  v_add_f32 v189, v189, v77
  v_add_f32 v190, v190, v78
  v_add_f32_e64 v191, v191, v79
  v_cvt_pk_bf16_f32 v220, v176, v177
  v_cvt_pk_bf16_f32 v221, v178, v179
  v_cvt_pk_bf16_f32 v222, v180, v181
  v_cvt_pk_bf16_f32 v223, v182, v183
  v_cvt_pk_bf16_f32 v224, v184, v185
  v_cvt_pk_bf16_f32 v225, v186, v187
  v_cvt_pk_bf16_f32 v226, v188, v189
  v_cvt_pk_bf16_f32 v227, v190, v191
  v_mfma_f32_32x32x16_bf16 v[64:79], v[220:223], v[128:131], 0
	s_nop 0
  s_nop 0
  v_mfma_f32_32x32x16_bf16 v[64:79], v[224:227], v[132:135], v[64:79]
  v_mfma_f32_32x32x16_bf16 v[80:95], v[220:223], v[136:139], 0
  v_mfma_f32_32x32x16_bf16 v[80:95], v[224:227], v[140:143], v[80:95]
  s_nop 9
  v_mul_f32 v64, v64, v144
  v_mul_f32 v65, v65, v144
  v_mul_f32 v66, v66, v144
  v_mul_f32 v67, v67, v144
  v_mul_f32 v68, v68, v144
  v_mul_f32 v69, v69, v144
  v_mul_f32 v70, v70, v144
  v_mul_f32 v71, v71, v144
  v_mul_f32 v72, v72, v144
  v_mul_f32 v73, v73, v144
  v_mul_f32 v74, v74, v144
  v_mul_f32 v75, v75, v144
  v_mul_f32 v76, v76, v144
  v_mul_f32 v77, v77, v144
  v_mul_f32 v78, v78, v144
  v_mul_f32_e64 v79, v79, v144
  v_cvt_pk_bf16_f32 v64, v64, v65
  v_cvt_pk_bf16_f32 v65, v66, v67
  v_cvt_pk_bf16_f32 v66, v68, v69
  v_cvt_pk_bf16_f32 v67, v70, v71
  v_cvt_pk_bf16_f32 v68, v72, v73
  v_cvt_pk_bf16_f32 v69, v74, v75
  v_cvt_pk_bf16_f32 v70, v76, v77
  v_cvt_pk_bf16_f32 v71, v78, v79
  buffer_store_dwordx4 v[64:67], v15, s[24:27], s46 offen sc1
  buffer_store_dwordx4 v[68:71], v15, s[24:27], s46 offen offset:1024 sc1
  v_mul_f32 v80, v80, v160
  v_mul_f32 v81, v81, v160
  v_mul_f32 v82, v82, v160
  v_mul_f32 v83, v83, v160
  v_mul_f32 v84, v84, v160
  v_mul_f32 v85, v85, v160
  v_mul_f32 v86, v86, v160
  v_mul_f32 v87, v87, v160
  v_mul_f32 v88, v88, v160
  v_mul_f32 v89, v89, v160
  v_mul_f32 v90, v90, v160
  v_mul_f32 v91, v91, v160
  v_mul_f32 v92, v92, v160
  v_mul_f32 v93, v93, v160
  v_mul_f32 v94, v94, v160
  v_mul_f32 v95, v95, v160
  v_cvt_pk_bf16_f32 v80, v80, v81
  v_cvt_pk_bf16_f32 v81, v82, v83
  v_cvt_pk_bf16_f32 v82, v84, v85
  v_cvt_pk_bf16_f32 v83, v86, v87
  v_cvt_pk_bf16_f32 v84, v88, v89
  v_cvt_pk_bf16_f32 v85, v90, v91
  v_cvt_pk_bf16_f32 v86, v92, v93
  v_cvt_pk_bf16_f32 v87, v94, v95
  s_add_u32 s46, s46, 65536
  buffer_store_dwordx4 v[80:83], v15, s[24:27], s46 offen sc1
  buffer_store_dwordx4 v[84:87], v15, s[24:27], s46 offen offset:1024 sc1
  v_lshrrev_b32 v20, 5, v1
  v_mul_u32_u24 v20, 4, v20
  v_bfe_u32 v21, v1, 2, 2
  v_add_u32 v20, v20, v21
  v_lshlrev_b32 v20, 7, v20
  v_bfe_u32 v21, v1, 3, 1
  v_lshlrev_b32_e64 v21, 6, v21
  v_bfe_u32 v22, v1, 4, 1
  v_lshlrev_b32_e64 v22, 5, v22
  v_add3_u32 v20, v20, v21, v22
  v_and_b32 v22, 3, v1
  v_lshlrev_b32 v22, 3, v22
  v_add3_u32 v12, v20, v22, 0
  v_xor_b32_e64 v13, 64, v12
  v_add_u32 v6, 49152, v12
  v_add_u32 v7, 49152, v13
  s_lshl_b32 s46, s44, 2
  s_add_u32 s56, s46, s40
  s_lshl_b32 s56, s56, 16
  s_lshl_b32 s52, s3, 12
  s_lshl_b32 s58, s44, 8
  s_add_u32 s58, s58, 4096
  s_lshl_b32 s69, s41, 8
  s_add_u32 s69, s69, 4096
  s_lshl_b32 s46, s42, 2
  s_add_u32 s69, s69, s46
  s_mov_b32 s36, s16
  s_mov_b32 s37, s17
  s_mov_b32 s38, 8388608
  s_mov_b32 s39, 0x00020000
  s_waitcnt vmcnt(0)
  s_barrier
  ds_read_b64_tr_b16 v[192:193], v6 offset:0
  ds_read_b64_tr_b16 v[194:195], v6 offset:1024
  ds_read_b64_tr_b16 v[196:197], v7 offset:0
  ds_read_b64_tr_b16 v[198:199], v7 offset:1024
  ds_read_b64_tr_b16 v[200:201], v6 offset:2048
  ds_read_b64_tr_b16 v[202:203], v6 offset:3072
  ds_read_b64_tr_b16 v[204:205], v7 offset:2048
  ds_read_b64_tr_b16 v[206:207], v7 offset:3072
  s_cmp_eq_u32 s40, 0
  s_cbranch_scc0 wl_7
  s_mov_b64 exec, 1
  buffer_store_dword v28, v27, s[60:63], s69 offen sc1
  s_mov_b64 exec, -1
wl_7:
  s_add_u32 m0, s51, 16384
	s_nop 0
  s_nop 0
  buffer_load_dwordx4 v30, s[12:15], s54 offen lds
  buffer_load_dwordx4 v31, s[12:15], s54 offen offset:1024 lds
  s_add_u32 s54, s54, 131072
  s_cmp_eq_u32 s54, 2097152
  s_cselect_b32 s54, 0, s54
  s_add_u32 m0, s51, 24576
  s_nop 0
  buffer_load_dwordx4 v30, s[12:15], s54 offen lds
  buffer_load_dwordx4 v31, s[12:15], s54 offen offset:1024 lds
  s_add_u32 s54, s54, 131072
  s_cmp_eq_u32 s54, 2097152
  s_cselect_b32 s54, 0, s54
  s_add_u32 m0, s51, 32768
  s_nop 0
  buffer_load_dwordx4 v30, s[12:15], s54 offen lds
  buffer_load_dwordx4 v31, s[12:15], s54 offen offset:1024 lds
  s_add_u32 s54, s54, 131072
  s_cmp_eq_u32 s54, 2097152
  s_cselect_b32 s54, 0, s54
  s_add_u32 m0, s51, 40960
  s_nop 0
  buffer_load_dwordx4 v30, s[12:15], s54 offen lds
  buffer_load_dwordx4 v31, s[12:15], s54 offen offset:1024 lds
  s_add_u32 s54, s54, 131072
  s_cmp_eq_u32 s54, 2097152
  s_cselect_b32 s54, 0, s54
  s_add_u32 m0, s51, 73728
  s_nop 0
  buffer_load_dwordx4 v30, s[12:15], s54 offen lds
  buffer_load_dwordx4 v31, s[12:15], s54 offen offset:1024 lds
  s_add_u32 s54, s54, 131072
  s_cmp_eq_u32 s54, 2097152
  s_cselect_b32 s54, 0, s54
  s_cmp_eq_u32 s40, 0
  s_cbranch_scc0 w0_8
  s_mov_b32 s59, 40000
spin_10:
  buffer_load_dword v26, v19, s[60:63], s58 offen sc1
  s_waitcnt vmcnt(0)
  v_cmp_ne_u32 vcc, 1, v26
  s_cbranch_vccz ok_9
  s_sleep 1
  s_sub_u32 s59, s59, 1
  s_cmp_lg_u32 s59, 0
  s_cbranch_scc1 spin_10
ok_9:
w0_8:
  s_waitcnt vmcnt(0)
  s_waitcnt lgkmcnt(0)
  s_barrier
  s_add_u32 s57, s56, s52
  buffer_load_dwordx4 v[64:67], v15, s[24:27], s57 offen sc1
  buffer_load_dwordx4 v[68:71], v15, s[24:27], s57 offen offset:1024 sc1
  buffer_load_dwordx4 v[72:75], v15, s[24:27], s57 offen offset:2048 sc1
  buffer_load_dwordx4 v[76:79], v15, s[24:27], s57 offen offset:3072 sc1
  s_add_u32 s52, s52, 4096
  s_and_b32 s52, s52, 0xffff
	s_nop 0
  s_add_u32 s57, s56, s52
  buffer_load_dwordx4 v[80:83], v15, s[24:27], s57 offen sc1
  buffer_load_dwordx4 v[84:87], v15, s[24:27], s57 offen offset:1024 sc1
  buffer_load_dwordx4 v[88:91], v15, s[24:27], s57 offen offset:2048 sc1
  buffer_load_dwordx4 v[92:95], v15, s[24:27], s57 offen offset:3072 sc1
  s_add_u32 s52, s52, 4096
  s_and_b32 s52, s52, 0xffff
	s_nop 0
  s_add_u32 s57, s56, s52
  buffer_load_dwordx4 v[96:99], v15, s[24:27], s57 offen sc1
  buffer_load_dwordx4 v[100:103], v15, s[24:27], s57 offen offset:1024 sc1
  buffer_load_dwordx4 v[104:107], v15, s[24:27], s57 offen offset:2048 sc1
  buffer_load_dwordx4 v[108:111], v15, s[24:27], s57 offen offset:3072 sc1
  s_add_u32 s52, s52, 4096
  s_and_b32 s52, s52, 0xffff
	s_nop 0
  s_add_u32 s57, s56, s52
  buffer_load_dwordx4 v[112:115], v15, s[24:27], s57 offen sc1
  buffer_load_dwordx4 v[116:119], v15, s[24:27], s57 offen offset:1024 sc1
  buffer_load_dwordx4 v[120:123], v15, s[24:27], s57 offen offset:2048 sc1
  buffer_load_dwordx4 v[124:127], v15, s[24:27], s57 offen offset:3072 sc1
  s_add_u32 s52, s52, 4096
  s_and_b32 s52, s52, 0xffff
	s_nop 0
  s_waitcnt vmcnt(15)
  v_mfma_f32_32x32x16_bf16 v[32:47], v[192:195], v[64:67], 0
  ds_read_b64_tr_b16 v[208:209], v6 offset:4096
  ds_read_b64_tr_b16 v[210:211], v6 offset:5120
  ds_read_b64_tr_b16 v[212:213], v7 offset:4096
  v_mfma_f32_32x32x16_bf16 v[48:63], v[196:199], v[64:67], 0
  ds_read_b64_tr_b16 v[214:215], v7 offset:5120
  ds_read_b64_tr_b16 v[216:217], v6 offset:6144
  ds_read_b64_tr_b16 v[218:219], v6 offset:7168
	s_nop 0
  s_waitcnt vmcnt(14)
  v_mfma_f32_32x32x16_bf16 v[32:47], v[200:203], v[68:71], v[32:47]
  ds_read_b64_tr_b16 v[220:221], v7 offset:6144
  ds_read_b64_tr_b16 v[222:223], v7 offset:7168
  v_mfma_f32_32x32x16_bf16 v[48:63], v[204:207], v[68:71], v[48:63]
	s_nop 0
  s_waitcnt vmcnt(13) lgkmcnt(6)
  v_mfma_f32_32x32x16_bf16 v[32:47], v[208:211], v[72:75], v[32:47]
  ds_read_b64_tr_b16 v[192:193], v6 offset:8192
  ds_read_b64_tr_b16 v[194:195], v6 offset:9216
  ds_read_b64_tr_b16 v[196:197], v7 offset:8192
  s_add_u32 s57, s56, s52
  buffer_load_dwordx4 v[128:131], v15, s[24:27], s57 offen sc1
  s_waitcnt lgkmcnt(7)
  v_mfma_f32_32x32x16_bf16 v[48:63], v[212:215], v[72:75], v[48:63]
  ds_read_b64_tr_b16 v[198:199], v7 offset:9216
  ds_read_b64_tr_b16 v[200:201], v6 offset:10240
  ds_read_b64_tr_b16 v[202:203], v6 offset:11264
  buffer_load_dwordx4 v[132:135], v15, s[24:27], s57 offen offset:1024 sc1
	s_nop 0
  s_waitcnt vmcnt(14) lgkmcnt(8)
  v_mfma_f32_32x32x16_bf16 v[32:47], v[216:219], v[76:79], v[32:47]
  ds_read_b64_tr_b16 v[204:205], v7 offset:10240
  ds_read_b64_tr_b16 v[206:207], v7 offset:11264
  buffer_load_dwordx4 v[136:139], v15, s[24:27], s57 offen offset:2048 sc1
	s_nop 0
  s_waitcnt lgkmcnt(8)
  v_mfma_f32_32x32x16_bf16 v[48:63], v[220:223], v[76:79], v[48:63]
  buffer_load_dwordx4 v[140:143], v15, s[24:27], s57 offen offset:3072 sc1
  s_add_u32 s52, s52, 4096
  s_and_b32 s52, s52, 0xffff
	s_nop 0
  s_waitcnt vmcnt(15) lgkmcnt(6)
  v_mfma_f32_32x32x16_bf16 v[32:47], v[192:195], v[80:83], v[32:47]
  ds_read_b64_tr_b16 v[208:209], v6 offset:12288
  ds_read_b64_tr_b16 v[210:211], v6 offset:13312
  ds_read_b64_tr_b16 v[212:213], v7 offset:12288
	s_nop 0
  s_waitcnt lgkmcnt(7)
  v_mfma_f32_32x32x16_bf16 v[48:63], v[196:199], v[80:83], v[48:63]
  ds_read_b64_tr_b16 v[214:215], v7 offset:13312
  ds_read_b64_tr_b16 v[216:217], v6 offset:14336
  ds_read_b64_tr_b16 v[218:219], v6 offset:15360
	s_nop 0
  s_waitcnt vmcnt(14) lgkmcnt(8)
  v_mfma_f32_32x32x16_bf16 v[32:47], v[200:203], v[84:87], v[32:47]
  ds_read_b64_tr_b16 v[220:221], v7 offset:14336
  ds_read_b64_tr_b16 v[222:223], v7 offset:15360
  s_waitcnt lgkmcnt(8)
  v_mfma_f32_32x32x16_bf16 v[48:63], v[204:207], v[84:87], v[48:63]
  s_waitcnt vmcnt(13) lgkmcnt(6)
  v_mfma_f32_32x32x16_bf16 v[32:47], v[208:211], v[88:91], v[32:47]
  ds_read_b64_tr_b16 v[192:193], v6 offset:16384
  ds_read_b64_tr_b16 v[194:195], v6 offset:17408
  ds_read_b64_tr_b16 v[196:197], v7 offset:16384
  s_add_u32 s57, s56, s52
  buffer_load_dwordx4 v[144:147], v15, s[24:27], s57 offen sc1
  s_waitcnt lgkmcnt(7)
  v_mfma_f32_32x32x16_bf16 v[48:63], v[212:215], v[88:91], v[48:63]
  ds_read_b64_tr_b16 v[198:199], v7 offset:17408
  ds_read_b64_tr_b16 v[200:201], v6 offset:18432
  ds_read_b64_tr_b16 v[202:203], v6 offset:19456
  buffer_load_dwordx4 v[148:151], v15, s[24:27], s57 offen offset:1024 sc1
	s_nop 0
  s_waitcnt vmcnt(14) lgkmcnt(8)
  v_mfma_f32_32x32x16_bf16 v[32:47], v[216:219], v[92:95], v[32:47]
  ds_read_b64_tr_b16 v[204:205], v7 offset:18432
  ds_read_b64_tr_b16 v[206:207], v7 offset:19456
  buffer_load_dwordx4 v[152:155], v15, s[24:27], s57 offen offset:2048 sc1
	s_nop 0
  s_waitcnt lgkmcnt(8)
  v_mfma_f32_32x32x16_bf16 v[48:63], v[220:223], v[92:95], v[48:63]
  buffer_load_dwordx4 v[156:159], v15, s[24:27], s57 offen offset:3072 sc1
  s_add_u32 s52, s52, 4096
  s_and_b32 s52, s52, 0xffff
	s_nop 0
  s_waitcnt vmcnt(15) lgkmcnt(6)
  v_mfma_f32_32x32x16_bf16 v[32:47], v[192:195], v[96:99], v[32:47]
  ds_read_b64_tr_b16 v[208:209], v6 offset:20480
  ds_read_b64_tr_b16 v[210:211], v6 offset:21504
  ds_read_b64_tr_b16 v[212:213], v7 offset:20480
	s_nop 0
  s_waitcnt lgkmcnt(7)
  v_mfma_f32_32x32x16_bf16 v[48:63], v[196:199], v[96:99], v[48:63]
  ds_read_b64_tr_b16 v[214:215], v7 offset:21504
  ds_read_b64_tr_b16 v[216:217], v6 offset:22528
  ds_read_b64_tr_b16 v[218:219], v6 offset:23552
	s_nop 0
  s_waitcnt vmcnt(14) lgkmcnt(8)
  v_mfma_f32_32x32x16_bf16 v[32:47], v[200:203], v[100:103], v[32:47]
  ds_read_b64_tr_b16 v[220:221], v7 offset:22528
  ds_read_b64_tr_b16 v[222:223], v7 offset:23552
  s_waitcnt lgkmcnt(8)
  v_mfma_f32_32x32x16_bf16 v[48:63], v[204:207], v[100:103], v[48:63]
  s_waitcnt vmcnt(13) lgkmcnt(6)
  v_mfma_f32_32x32x16_bf16 v[32:47], v[208:211], v[104:107], v[32:47]
  ds_read_b64_tr_b16 v[192:193], v12 offset:0
  ds_read_b64_tr_b16 v[194:195], v12 offset:1024
  ds_read_b64_tr_b16 v[196:197], v13 offset:0
  s_add_u32 s57, s56, s52
  buffer_load_dwordx4 v[160:163], v15, s[24:27], s57 offen sc1
  s_waitcnt lgkmcnt(7)
  v_mfma_f32_32x32x16_bf16 v[48:63], v[212:215], v[104:107], v[48:63]
  ds_read_b64_tr_b16 v[198:199], v13 offset:1024
  ds_read_b64_tr_b16 v[200:201], v12 offset:2048
  ds_read_b64_tr_b16 v[202:203], v12 offset:3072
  buffer_load_dwordx4 v[164:167], v15, s[24:27], s57 offen offset:1024 sc1
	s_nop 0
  s_waitcnt vmcnt(14) lgkmcnt(8)
  v_mfma_f32_32x32x16_bf16 v[32:47], v[216:219], v[108:111], v[32:47]
  ds_read_b64_tr_b16 v[204:205], v13 offset:2048
  ds_read_b64_tr_b16 v[206:207], v13 offset:3072
  buffer_load_dwordx4 v[168:171], v15, s[24:27], s57 offen offset:2048 sc1
	s_nop 0
  s_waitcnt lgkmcnt(8)
  v_mfma_f32_32x32x16_bf16 v[48:63], v[220:223], v[108:111], v[48:63]
  buffer_load_dwordx4 v[172:175], v15, s[24:27], s57 offen offset:3072 sc1
  s_add_u32 s52, s52, 4096
  s_and_b32 s52, s52, 0xffff
	s_nop 0
  s_waitcnt vmcnt(15) lgkmcnt(6)
  v_mfma_f32_32x32x16_bf16 v[32:47], v[192:195], v[112:115], v[32:47]
  ds_read_b64_tr_b16 v[208:209], v12 offset:4096
  ds_read_b64_tr_b16 v[210:211], v12 offset:5120
  ds_read_b64_tr_b16 v[212:213], v13 offset:4096
	s_nop 0
  s_waitcnt lgkmcnt(7)
  v_mfma_f32_32x32x16_bf16 v[48:63], v[196:199], v[112:115], v[48:63]
  ds_read_b64_tr_b16 v[214:215], v13 offset:5120
  ds_read_b64_tr_b16 v[216:217], v12 offset:6144
  ds_read_b64_tr_b16 v[218:219], v12 offset:7168
	s_nop 0
  s_waitcnt vmcnt(14) lgkmcnt(8)
  v_mfma_f32_32x32x16_bf16 v[32:47], v[200:203], v[116:119], v[32:47]
  ds_read_b64_tr_b16 v[220:221], v13 offset:6144
  ds_read_b64_tr_b16 v[222:223], v13 offset:7168
  s_waitcnt lgkmcnt(8)
  v_mfma_f32_32x32x16_bf16 v[48:63], v[204:207], v[116:119], v[48:63]
  s_waitcnt vmcnt(13) lgkmcnt(6)
  v_mfma_f32_32x32x16_bf16 v[32:47], v[208:211], v[120:123], v[32:47]
  ds_read_b64_tr_b16 v[192:193], v12 offset:8192
  ds_read_b64_tr_b16 v[194:195], v12 offset:9216
  ds_read_b64_tr_b16 v[196:197], v13 offset:8192
  s_add_u32 s57, s56, s52
  buffer_load_dwordx4 v[176:179], v15, s[24:27], s57 offen sc1
  s_waitcnt lgkmcnt(7)
  v_mfma_f32_32x32x16_bf16 v[48:63], v[212:215], v[120:123], v[48:63]
  ds_read_b64_tr_b16 v[198:199], v13 offset:9216
  ds_read_b64_tr_b16 v[200:201], v12 offset:10240
  ds_read_b64_tr_b16 v[202:203], v12 offset:11264
  buffer_load_dwordx4 v[180:183], v15, s[24:27], s57 offen offset:1024 sc1
	s_nop 0
  s_waitcnt vmcnt(14) lgkmcnt(8)
  v_mfma_f32_32x32x16_bf16 v[32:47], v[216:219], v[124:127], v[32:47]
  ds_read_b64_tr_b16 v[204:205], v13 offset:10240
  ds_read_b64_tr_b16 v[206:207], v13 offset:11264
  buffer_load_dwordx4 v[184:187], v15, s[24:27], s57 offen offset:2048 sc1
	s_nop 0
  s_waitcnt lgkmcnt(8)
  v_mfma_f32_32x32x16_bf16 v[48:63], v[220:223], v[124:127], v[48:63]
  buffer_load_dwordx4 v[188:191], v15, s[24:27], s57 offen offset:3072 sc1
  s_add_u32 s52, s52, 4096
  s_and_b32 s52, s52, 0xffff
	s_nop 0
  s_waitcnt vmcnt(15) lgkmcnt(6)
  v_mfma_f32_32x32x16_bf16 v[32:47], v[192:195], v[128:131], v[32:47]
  ds_read_b64_tr_b16 v[208:209], v12 offset:12288
  ds_read_b64_tr_b16 v[210:211], v12 offset:13312
  ds_read_b64_tr_b16 v[212:213], v13 offset:12288
	s_nop 0
  s_waitcnt lgkmcnt(7)
  v_mfma_f32_32x32x16_bf16 v[48:63], v[196:199], v[128:131], v[48:63]
  ds_read_b64_tr_b16 v[214:215], v13 offset:13312
  ds_read_b64_tr_b16 v[216:217], v12 offset:14336
  ds_read_b64_tr_b16 v[218:219], v12 offset:15360
	s_nop 0
  s_waitcnt vmcnt(14) lgkmcnt(8)
  v_mfma_f32_32x32x16_bf16 v[32:47], v[200:203], v[132:135], v[32:47]
  ds_read_b64_tr_b16 v[220:221], v13 offset:14336
  ds_read_b64_tr_b16 v[222:223], v13 offset:15360
  s_waitcnt lgkmcnt(8)
  v_mfma_f32_32x32x16_bf16 v[48:63], v[204:207], v[132:135], v[48:63]
  s_waitcnt vmcnt(13) lgkmcnt(6)
  v_mfma_f32_32x32x16_bf16 v[32:47], v[208:211], v[136:139], v[32:47]
  ds_read_b64_tr_b16 v[192:193], v12 offset:16384
  ds_read_b64_tr_b16 v[194:195], v12 offset:17408
  ds_read_b64_tr_b16 v[196:197], v13 offset:16384
  s_add_u32 s57, s56, s52
  buffer_load_dwordx4 v[64:67], v15, s[24:27], s57 offen sc1
  s_waitcnt lgkmcnt(7)
  v_mfma_f32_32x32x16_bf16 v[48:63], v[212:215], v[136:139], v[48:63]
  ds_read_b64_tr_b16 v[198:199], v13 offset:17408
  ds_read_b64_tr_b16 v[200:201], v12 offset:18432
  ds_read_b64_tr_b16 v[202:203], v12 offset:19456
  buffer_load_dwordx4 v[68:71], v15, s[24:27], s57 offen offset:1024 sc1
	s_nop 0
  s_waitcnt vmcnt(14) lgkmcnt(8)
  v_mfma_f32_32x32x16_bf16 v[32:47], v[216:219], v[140:143], v[32:47]
  ds_read_b64_tr_b16 v[204:205], v13 offset:18432
  ds_read_b64_tr_b16 v[206:207], v13 offset:19456
  buffer_load_dwordx4 v[72:75], v15, s[24:27], s57 offen offset:2048 sc1
	s_nop 0
  s_waitcnt lgkmcnt(8)
  v_mfma_f32_32x32x16_bf16 v[48:63], v[220:223], v[140:143], v[48:63]
  buffer_load_dwordx4 v[76:79], v15, s[24:27], s57 offen offset:3072 sc1
  s_add_u32 s52, s52, 4096
  s_and_b32 s52, s52, 0xffff
	s_nop 0
  s_waitcnt vmcnt(15) lgkmcnt(6)
  v_mfma_f32_32x32x16_bf16 v[32:47], v[192:195], v[144:147], v[32:47]
  ds_read_b64_tr_b16 v[208:209], v12 offset:20480
  ds_read_b64_tr_b16 v[210:211], v12 offset:21504
  ds_read_b64_tr_b16 v[212:213], v13 offset:20480
	s_nop 0
  s_waitcnt lgkmcnt(7)
  v_mfma_f32_32x32x16_bf16 v[48:63], v[196:199], v[144:147], v[48:63]
  ds_read_b64_tr_b16 v[214:215], v13 offset:21504
  ds_read_b64_tr_b16 v[216:217], v12 offset:22528
  ds_read_b64_tr_b16 v[218:219], v12 offset:23552
	s_nop 0
  s_waitcnt vmcnt(14) lgkmcnt(8)
  v_mfma_f32_32x32x16_bf16 v[32:47], v[200:203], v[148:151], v[32:47]
  ds_read_b64_tr_b16 v[220:221], v13 offset:22528
  ds_read_b64_tr_b16 v[222:223], v13 offset:23552
  s_waitcnt lgkmcnt(8)
  v_mfma_f32_32x32x16_bf16 v[48:63], v[204:207], v[148:151], v[48:63]
  s_waitcnt vmcnt(13) lgkmcnt(6)
  v_mfma_f32_32x32x16_bf16 v[32:47], v[208:211], v[152:155], v[32:47]
  ds_read_b64_tr_b16 v[192:193], v12 offset:24576
  ds_read_b64_tr_b16 v[194:195], v12 offset:25600
  ds_read_b64_tr_b16 v[196:197], v13 offset:24576
  s_add_u32 s57, s56, s52
  buffer_load_dwordx4 v[80:83], v15, s[24:27], s57 offen sc1
  s_waitcnt lgkmcnt(7)
  v_mfma_f32_32x32x16_bf16 v[48:63], v[212:215], v[152:155], v[48:63]
  ds_read_b64_tr_b16 v[198:199], v13 offset:25600
  ds_read_b64_tr_b16 v[200:201], v12 offset:26624
  ds_read_b64_tr_b16 v[202:203], v12 offset:27648
  buffer_load_dwordx4 v[84:87], v15, s[24:27], s57 offen offset:1024 sc1
	s_nop 0
  s_waitcnt vmcnt(14) lgkmcnt(8)
  v_mfma_f32_32x32x16_bf16 v[32:47], v[216:219], v[156:159], v[32:47]
  ds_read_b64_tr_b16 v[204:205], v13 offset:26624
  ds_read_b64_tr_b16 v[206:207], v13 offset:27648
  buffer_load_dwordx4 v[88:91], v15, s[24:27], s57 offen offset:2048 sc1
	s_nop 0
  s_waitcnt lgkmcnt(8)
  v_mfma_f32_32x32x16_bf16 v[48:63], v[220:223], v[156:159], v[48:63]
  buffer_load_dwordx4 v[92:95], v15, s[24:27], s57 offen offset:3072 sc1
  s_add_u32 s52, s52, 4096
  s_and_b32 s52, s52, 0xffff
	s_nop 0
  s_waitcnt vmcnt(15) lgkmcnt(6)
  v_mfma_f32_32x32x16_bf16 v[32:47], v[192:195], v[160:163], v[32:47]
  ds_read_b64_tr_b16 v[208:209], v12 offset:28672
  ds_read_b64_tr_b16 v[210:211], v12 offset:29696
  ds_read_b64_tr_b16 v[212:213], v13 offset:28672
	s_nop 0
  s_waitcnt lgkmcnt(7)
  v_mfma_f32_32x32x16_bf16 v[48:63], v[196:199], v[160:163], v[48:63]
  ds_read_b64_tr_b16 v[214:215], v13 offset:29696
  ds_read_b64_tr_b16 v[216:217], v12 offset:30720
  ds_read_b64_tr_b16 v[218:219], v12 offset:31744
	s_nop 0
  s_waitcnt vmcnt(14) lgkmcnt(8)
  v_mfma_f32_32x32x16_bf16 v[32:47], v[200:203], v[164:167], v[32:47]
  ds_read_b64_tr_b16 v[220:221], v13 offset:30720
  ds_read_b64_tr_b16 v[222:223], v13 offset:31744
  s_waitcnt lgkmcnt(8)
  v_mfma_f32_32x32x16_bf16 v[48:63], v[204:207], v[164:167], v[48:63]
  s_waitcnt vmcnt(13) lgkmcnt(6)
  v_mfma_f32_32x32x16_bf16 v[32:47], v[208:211], v[168:171], v[32:47]
  ds_read_b64_tr_b16 v[192:193], v12 offset:32768
  ds_read_b64_tr_b16 v[194:195], v12 offset:33792
  ds_read_b64_tr_b16 v[196:197], v13 offset:32768
  s_add_u32 s57, s56, s52
  buffer_load_dwordx4 v[96:99], v15, s[24:27], s57 offen sc1
  s_waitcnt lgkmcnt(7)
  v_mfma_f32_32x32x16_bf16 v[48:63], v[212:215], v[168:171], v[48:63]
  ds_read_b64_tr_b16 v[198:199], v13 offset:33792
  ds_read_b64_tr_b16 v[200:201], v12 offset:34816
  ds_read_b64_tr_b16 v[202:203], v12 offset:35840
  buffer_load_dwordx4 v[100:103], v15, s[24:27], s57 offen offset:1024 sc1
	s_nop 0
  s_waitcnt vmcnt(14) lgkmcnt(8)
  v_mfma_f32_32x32x16_bf16 v[32:47], v[216:219], v[172:175], v[32:47]
  ds_read_b64_tr_b16 v[204:205], v13 offset:34816
  ds_read_b64_tr_b16 v[206:207], v13 offset:35840
  buffer_load_dwordx4 v[104:107], v15, s[24:27], s57 offen offset:2048 sc1
	s_nop 0
  s_waitcnt lgkmcnt(8)
  v_mfma_f32_32x32x16_bf16 v[48:63], v[220:223], v[172:175], v[48:63]
  buffer_load_dwordx4 v[108:111], v15, s[24:27], s57 offen offset:3072 sc1
  s_add_u32 s52, s52, 4096
  s_and_b32 s52, s52, 0xffff
  s_waitcnt lgkmcnt(0)
  s_barrier
	s_nop 0
  s_waitcnt vmcnt(15)
  v_mfma_f32_32x32x16_bf16 v[32:47], v[192:195], v[176:179], v[32:47]
  s_add_u32 m0, s51, 49152
  ds_read_b64_tr_b16 v[208:209], v12 offset:36864
  ds_read_b64_tr_b16 v[210:211], v12 offset:37888
  ds_read_b64_tr_b16 v[212:213], v13 offset:36864
  buffer_load_dwordx4 v30, s[12:15], s54 offen lds
  v_mfma_f32_32x32x16_bf16 v[48:63], v[196:199], v[176:179], v[48:63]
  ds_read_b64_tr_b16 v[214:215], v13 offset:37888
  ds_read_b64_tr_b16 v[216:217], v12 offset:38912
  ds_read_b64_tr_b16 v[218:219], v12 offset:39936
  buffer_load_dwordx4 v31, s[12:15], s54 offen offset:1024 lds
  s_add_u32 s54, s54, 131072
  s_cmp_eq_u32 s54, 2097152
  s_cselect_b32 s54, 0, s54
  s_waitcnt vmcnt(16)
  v_mfma_f32_32x32x16_bf16 v[32:47], v[200:203], v[180:183], v[32:47]
  s_add_u32 m0, s51, 57344
  ds_read_b64_tr_b16 v[220:221], v13 offset:38912
  ds_read_b64_tr_b16 v[222:223], v13 offset:39936
  buffer_load_dwordx4 v30, s[12:15], s54 offen lds
  v_mfma_f32_32x32x16_bf16 v[48:63], v[204:207], v[180:183], v[48:63]
  buffer_load_dwordx4 v31, s[12:15], s54 offen offset:1024 lds
  s_add_u32 s54, s54, 131072
  s_cmp_eq_u32 s54, 2097152
  s_cselect_b32 s54, 0, s54
  s_waitcnt vmcnt(17) lgkmcnt(6)
  v_mfma_f32_32x32x16_bf16 v[32:47], v[208:211], v[184:187], v[32:47]
  s_add_u32 m0, s51, 65536
  ds_read_b64_tr_b16 v[192:193], v12 offset:40960
  ds_read_b64_tr_b16 v[194:195], v12 offset:41984
  ds_read_b64_tr_b16 v[196:197], v13 offset:40960
  s_add_u32 s57, s56, s52
  buffer_load_dwordx4 v[112:115], v15, s[24:27], s57 offen sc1
  buffer_load_dwordx4 v30, s[12:15], s54 offen lds
  s_waitcnt lgkmcnt(7)
  v_mfma_f32_32x32x16_bf16 v[48:63], v[212:215], v[184:187], v[48:63]
  ds_read_b64_tr_b16 v[198:199], v13 offset:41984
  ds_read_b64_tr_b16 v[200:201], v12 offset:43008
  ds_read_b64_tr_b16 v[202:203], v12 offset:44032
  buffer_load_dwordx4 v[116:119], v15, s[24:27], s57 offen offset:1024 sc1
  buffer_load_dwordx4 v31, s[12:15], s54 offen offset:1024 lds
  s_add_u32 s54, s54, 131072
  s_cmp_eq_u32 s54, 2097152
  s_cselect_b32 s54, 0, s54
  s_waitcnt vmcnt(20) lgkmcnt(8)
  v_mfma_f32_32x32x16_bf16 v[32:47], v[216:219], v[188:191], v[32:47]
	s_nop 0
  s_add_u32 m0, s51, 0
  ds_read_b64_tr_b16 v[204:205], v13 offset:43008
  ds_read_b64_tr_b16 v[206:207], v13 offset:44032
  buffer_load_dwordx4 v[120:123], v15, s[24:27], s57 offen offset:2048 sc1
  buffer_load_dwordx4 v30, s[12:15], s54 offen lds
	s_nop 0
  s_waitcnt lgkmcnt(8)
  v_mfma_f32_32x32x16_bf16 v[48:63], v[220:223], v[188:191], v[48:63]
  buffer_load_dwordx4 v[124:127], v15, s[24:27], s57 offen offset:3072 sc1
  s_add_u32 s52, s52, 4096
  s_and_b32 s52, s52, 0xffff
  buffer_load_dwordx4 v31, s[12:15], s54 offen offset:1024 lds
  s_add_u32 s54, s54, 131072
  s_cmp_eq_u32 s54, 2097152
  s_cselect_b32 s54, 0, s54
  s_waitcnt vmcnt(23) lgkmcnt(6)
  v_mfma_f32_32x32x16_bf16 v[32:47], v[192:195], v[64:67], v[32:47]
  s_add_u32 m0, s51, 8192
  ds_read_b64_tr_b16 v[208:209], v12 offset:45056
  ds_read_b64_tr_b16 v[210:211], v12 offset:46080
  ds_read_b64_tr_b16 v[212:213], v13 offset:45056
  buffer_load_dwordx4 v30, s[12:15], s54 offen lds
	s_nop 0
  s_waitcnt lgkmcnt(7)
  v_mfma_f32_32x32x16_bf16 v[48:63], v[196:199], v[64:67], v[48:63]
  ds_read_b64_tr_b16 v[214:215], v13 offset:46080
  ds_read_b64_tr_b16 v[216:217], v12 offset:47104
  ds_read_b64_tr_b16 v[218:219], v12 offset:48128
  buffer_load_dwordx4 v31, s[12:15], s54 offen offset:1024 lds
  s_add_u32 s54, s54, 131072
  s_cmp_eq_u32 s54, 2097152
  s_cselect_b32 s54, 0, s54
  s_waitcnt vmcnt(24) lgkmcnt(8)
  v_mfma_f32_32x32x16_bf16 v[32:47], v[200:203], v[68:71], v[32:47]
  s_add_u32 m0, s51, 16384
  ds_read_b64_tr_b16 v[220:221], v13 offset:47104
  ds_read_b64_tr_b16 v[222:223], v13 offset:48128
  buffer_load_dwordx4 v30, s[12:15], s54 offen lds
	s_nop 0
  s_waitcnt lgkmcnt(8)
  v_mfma_f32_32x32x16_bf16 v[48:63], v[204:207], v[68:71], v[48:63]
  buffer_load_dwordx4 v31, s[12:15], s54 offen offset:1024 lds
  s_add_u32 s54, s54, 131072
  s_cmp_eq_u32 s54, 2097152
  s_cselect_b32 s54, 0, s54
  s_waitcnt vmcnt(25) lgkmcnt(6)
  v_mfma_f32_32x32x16_bf16 v[32:47], v[208:211], v[72:75], v[32:47]
  ds_read_b64_tr_b16 v[192:193], v6 offset:24576
  ds_read_b64_tr_b16 v[194:195], v6 offset:25600
  ds_read_b64_tr_b16 v[196:197], v7 offset:24576
  s_add_u32 s57, s56, s52
  buffer_load_dwordx4 v[128:131], v15, s[24:27], s57 offen sc1
  s_waitcnt lgkmcnt(7)
  v_mfma_f32_32x32x16_bf16 v[48:63], v[212:215], v[72:75], v[48:63]
  ds_read_b64_tr_b16 v[198:199], v7 offset:25600
  ds_read_b64_tr_b16 v[200:201], v6 offset:26624
  ds_read_b64_tr_b16 v[202:203], v6 offset:27648
  buffer_load_dwordx4 v[132:135], v15, s[24:27], s57 offen offset:1024 sc1
	s_nop 0
  s_waitcnt vmcnt(26) lgkmcnt(8)
  v_mfma_f32_32x32x16_bf16 v[32:47], v[216:219], v[76:79], v[32:47]
  ds_read_b64_tr_b16 v[204:205], v7 offset:26624
  ds_read_b64_tr_b16 v[206:207], v7 offset:27648
  buffer_load_dwordx4 v[136:139], v15, s[24:27], s57 offen offset:2048 sc1
	s_nop 0
  s_waitcnt lgkmcnt(8)
  v_mfma_f32_32x32x16_bf16 v[48:63], v[220:223], v[76:79], v[48:63]
  buffer_load_dwordx4 v[140:143], v15, s[24:27], s57 offen offset:3072 sc1
  s_add_u32 s52, s52, 4096
  s_and_b32 s52, s52, 0xffff
	s_nop 0
  s_waitcnt vmcnt(27) lgkmcnt(6)
  v_mfma_f32_32x32x16_bf16 v[32:47], v[192:195], v[80:83], v[32:47]
  ds_read_b64_tr_b16 v[208:209], v6 offset:28672
  ds_read_b64_tr_b16 v[210:211], v6 offset:29696
  ds_read_b64_tr_b16 v[212:213], v7 offset:28672
	s_nop 0
  s_waitcnt lgkmcnt(7)
  v_mfma_f32_32x32x16_bf16 v[48:63], v[196:199], v[80:83], v[48:63]
  ds_read_b64_tr_b16 v[214:215], v7 offset:29696
  ds_read_b64_tr_b16 v[216:217], v6 offset:30720
  ds_read_b64_tr_b16 v[218:219], v6 offset:31744
	s_nop 0
  s_waitcnt vmcnt(26) lgkmcnt(8)
  v_mfma_f32_32x32x16_bf16 v[32:47], v[200:203], v[84:87], v[32:47]
  ds_read_b64_tr_b16 v[220:221], v7 offset:30720
  ds_read_b64_tr_b16 v[222:223], v7 offset:31744
  s_waitcnt lgkmcnt(8)
  v_mfma_f32_32x32x16_bf16 v[48:63], v[204:207], v[84:87], v[48:63]
  s_waitcnt vmcnt(16)
  s_waitcnt lgkmcnt(0)
  s_barrier
  v_mfma_f32_32x32x16_bf16 v[32:47], v[208:211], v[88:91], v[32:47]
  ds_read_b64_tr_b16 v[192:193], v6 offset:0
  ds_read_b64_tr_b16 v[194:195], v6 offset:1024
  ds_read_b64_tr_b16 v[196:197], v7 offset:0
	s_nop 0
  s_add_u32 s57, s56, s52
  buffer_load_dwordx4 v[144:147], v15, s[24:27], s57 offen sc1
  v_mfma_f32_32x32x16_bf16 v[48:63], v[212:215], v[88:91], v[48:63]
  ds_read_b64_tr_b16 v[198:199], v7 offset:1024
  ds_read_b64_tr_b16 v[200:201], v6 offset:2048
  ds_read_b64_tr_b16 v[202:203], v6 offset:3072
  buffer_load_dwordx4 v[148:151], v15, s[24:27], s57 offen offset:1024 sc1
  v_mfma_f32_32x32x16_bf16 v[32:47], v[216:219], v[92:95], v[32:47]
  ds_read_b64_tr_b16 v[204:205], v7 offset:2048
  ds_read_b64_tr_b16 v[206:207], v7 offset:3072
  buffer_load_dwordx4 v[152:155], v15, s[24:27], s57 offen offset:2048 sc1
  v_mfma_f32_32x32x16_bf16 v[48:63], v[220:223], v[92:95], v[48:63]
  buffer_load_dwordx4 v[156:159], v15, s[24:27], s57 offen offset:3072 sc1
  s_add_u32 s52, s52, 4096
  s_and_b32 s52, s52, 0xffff
	s_nop 0
  s_waitcnt lgkmcnt(6)
  v_mfma_f32_32x32x16_bf16 v[32:47], v[192:195], v[96:99], v[32:47]
  ds_read_b64_tr_b16 v[208:209], v6 offset:4096
  ds_read_b64_tr_b16 v[210:211], v6 offset:5120
  ds_read_b64_tr_b16 v[212:213], v7 offset:4096
	s_nop 0
  s_waitcnt lgkmcnt(7)
  v_mfma_f32_32x32x16_bf16 v[48:63], v[196:199], v[96:99], v[48:63]
  ds_read_b64_tr_b16 v[214:215], v7 offset:5120
  ds_read_b64_tr_b16 v[216:217], v6 offset:6144
  ds_read_b64_tr_b16 v[218:219], v6 offset:7168
	s_nop 0
  s_waitcnt lgkmcnt(8)
  v_mfma_f32_32x32x16_bf16 v[32:47], v[200:203], v[100:103], v[32:47]
  ds_read_b64_tr_b16 v[220:221], v7 offset:6144
  ds_read_b64_tr_b16 v[222:223], v7 offset:7168
  s_waitcnt lgkmcnt(8)
  v_mfma_f32_32x32x16_bf16 v[48:63], v[204:207], v[100:103], v[48:63]
  s_waitcnt lgkmcnt(6)
  v_mfma_f32_32x32x16_bf16 v[32:47], v[208:211], v[104:107], v[32:47]
  ds_read_b64_tr_b16 v[192:193], v6 offset:8192
  ds_read_b64_tr_b16 v[194:195], v6 offset:9216
  ds_read_b64_tr_b16 v[196:197], v7 offset:8192
  s_add_u32 s57, s56, s52
  buffer_load_dwordx4 v[160:163], v15, s[24:27], s57 offen sc1
  s_waitcnt lgkmcnt(7)
  v_mfma_f32_32x32x16_bf16 v[48:63], v[212:215], v[104:107], v[48:63]
  ds_read_b64_tr_b16 v[198:199], v7 offset:9216
  ds_read_b64_tr_b16 v[200:201], v6 offset:10240
  ds_read_b64_tr_b16 v[202:203], v6 offset:11264
  buffer_load_dwordx4 v[164:167], v15, s[24:27], s57 offen offset:1024 sc1
	s_nop 0
  s_waitcnt lgkmcnt(8)
  v_mfma_f32_32x32x16_bf16 v[32:47], v[216:219], v[108:111], v[32:47]
  ds_read_b64_tr_b16 v[204:205], v7 offset:10240
  ds_read_b64_tr_b16 v[206:207], v7 offset:11264
  buffer_load_dwordx4 v[168:171], v15, s[24:27], s57 offen offset:2048 sc1
	s_nop 0
  s_waitcnt lgkmcnt(8)
  v_mfma_f32_32x32x16_bf16 v[48:63], v[220:223], v[108:111], v[48:63]
  buffer_load_dwordx4 v[172:175], v15, s[24:27], s57 offen offset:3072 sc1
  s_add_u32 s52, s52, 4096
  s_and_b32 s52, s52, 0xffff
	s_nop 0
  s_waitcnt vmcnt(23) lgkmcnt(6)
  v_mfma_f32_32x32x16_bf16 v[32:47], v[192:195], v[112:115], v[32:47]
  ds_read_b64_tr_b16 v[208:209], v6 offset:12288
  ds_read_b64_tr_b16 v[210:211], v6 offset:13312
  ds_read_b64_tr_b16 v[212:213], v7 offset:12288
	s_nop 0
  s_waitcnt lgkmcnt(7)
  v_mfma_f32_32x32x16_bf16 v[48:63], v[196:199], v[112:115], v[48:63]
  ds_read_b64_tr_b16 v[214:215], v7 offset:13312
  ds_read_b64_tr_b16 v[216:217], v6 offset:14336
  ds_read_b64_tr_b16 v[218:219], v6 offset:15360
	s_nop 0
  s_waitcnt vmcnt(21) lgkmcnt(8)
  v_mfma_f32_32x32x16_bf16 v[32:47], v[200:203], v[116:119], v[32:47]
  ds_read_b64_tr_b16 v[220:221], v7 offset:14336
  ds_read_b64_tr_b16 v[222:223], v7 offset:15360
  s_waitcnt lgkmcnt(8)
  v_mfma_f32_32x32x16_bf16 v[48:63], v[204:207], v[116:119], v[48:63]
  s_waitcnt vmcnt(16)
  s_waitcnt lgkmcnt(0)
  s_barrier
  v_mfma_f32_32x32x16_bf16 v[32:47], v[208:211], v[120:123], v[32:47]
  ds_read_b64_tr_b16 v[192:193], v6 offset:16384
  ds_read_b64_tr_b16 v[194:195], v6 offset:17408
  ds_read_b64_tr_b16 v[196:197], v7 offset:16384
	s_nop 0
  s_add_u32 s57, s56, s52
  buffer_load_dwordx4 v[176:179], v15, s[24:27], s57 offen sc1
  v_mfma_f32_32x32x16_bf16 v[48:63], v[212:215], v[120:123], v[48:63]
  ds_read_b64_tr_b16 v[198:199], v7 offset:17408
  ds_read_b64_tr_b16 v[200:201], v6 offset:18432
  ds_read_b64_tr_b16 v[202:203], v6 offset:19456
  buffer_load_dwordx4 v[180:183], v15, s[24:27], s57 offen offset:1024 sc1
  v_mfma_f32_32x32x16_bf16 v[32:47], v[216:219], v[124:127], v[32:47]
  ds_read_b64_tr_b16 v[204:205], v7 offset:18432
  ds_read_b64_tr_b16 v[206:207], v7 offset:19456
  buffer_load_dwordx4 v[184:187], v15, s[24:27], s57 offen offset:2048 sc1
  v_mfma_f32_32x32x16_bf16 v[48:63], v[220:223], v[124:127], v[48:63]
  buffer_load_dwordx4 v[188:191], v15, s[24:27], s57 offen offset:3072 sc1
  s_add_u32 s52, s52, 4096
  s_and_b32 s52, s52, 0xffff
	s_nop 0
  s_waitcnt vmcnt(15) lgkmcnt(6)
  v_mfma_f32_32x32x16_bf16 v[32:47], v[192:195], v[128:131], v[32:47]
  ds_read_b64_tr_b16 v[208:209], v6 offset:20480
  ds_read_b64_tr_b16 v[210:211], v6 offset:21504
  ds_read_b64_tr_b16 v[212:213], v7 offset:20480
	s_nop 0
  s_waitcnt lgkmcnt(7)
  v_mfma_f32_32x32x16_bf16 v[48:63], v[196:199], v[128:131], v[48:63]
  ds_read_b64_tr_b16 v[214:215], v7 offset:21504
  ds_read_b64_tr_b16 v[216:217], v6 offset:22528
  ds_read_b64_tr_b16 v[218:219], v6 offset:23552
	s_nop 0
  s_waitcnt vmcnt(14) lgkmcnt(8)
  v_mfma_f32_32x32x16_bf16 v[32:47], v[200:203], v[132:135], v[32:47]
  ds_read_b64_tr_b16 v[220:221], v7 offset:22528
  ds_read_b64_tr_b16 v[222:223], v7 offset:23552
  s_waitcnt lgkmcnt(8)
  v_mfma_f32_32x32x16_bf16 v[48:63], v[204:207], v[132:135], v[48:63]
  s_waitcnt vmcnt(13) lgkmcnt(6)
  v_mfma_f32_32x32x16_bf16 v[32:47], v[208:211], v[136:139], v[32:47]
  ds_read_b64_tr_b16 v[192:193], v12 offset:0
  ds_read_b64_tr_b16 v[194:195], v12 offset:1024
  ds_read_b64_tr_b16 v[196:197], v13 offset:0
	s_nop 0
  s_waitcnt lgkmcnt(7)
  v_mfma_f32_32x32x16_bf16 v[48:63], v[212:215], v[136:139], v[48:63]
  ds_read_b64_tr_b16 v[198:199], v13 offset:1024
  ds_read_b64_tr_b16 v[200:201], v12 offset:2048
  ds_read_b64_tr_b16 v[202:203], v12 offset:3072
	s_nop 0
  s_waitcnt vmcnt(12) lgkmcnt(8)
  v_mfma_f32_32x32x16_bf16 v[32:47], v[216:219], v[140:143], v[32:47]
  ds_read_b64_tr_b16 v[204:205], v13 offset:2048
  ds_read_b64_tr_b16 v[206:207], v13 offset:3072
  s_waitcnt lgkmcnt(8)
  v_mfma_f32_32x32x16_bf16 v[48:63], v[220:223], v[140:143], v[48:63]
  s_waitcnt vmcnt(11) lgkmcnt(6)
  v_mfma_f32_32x32x16_bf16 v[32:47], v[192:195], v[144:147], v[32:47]
  ds_read_b64_tr_b16 v[208:209], v12 offset:4096
  ds_read_b64_tr_b16 v[210:211], v12 offset:5120
  ds_read_b64_tr_b16 v[212:213], v13 offset:4096
	s_nop 0
  s_waitcnt lgkmcnt(7)
  v_mfma_f32_32x32x16_bf16 v[48:63], v[196:199], v[144:147], v[48:63]
  ds_read_b64_tr_b16 v[214:215], v13 offset:5120
  ds_read_b64_tr_b16 v[216:217], v12 offset:6144
  ds_read_b64_tr_b16 v[218:219], v12 offset:7168
	s_nop 0
  s_waitcnt vmcnt(10) lgkmcnt(8)
  v_mfma_f32_32x32x16_bf16 v[32:47], v[200:203], v[148:151], v[32:47]
  ds_read_b64_tr_b16 v[220:221], v13 offset:6144
  ds_read_b64_tr_b16 v[222:223], v13 offset:7168
  s_waitcnt lgkmcnt(8)
  v_mfma_f32_32x32x16_bf16 v[48:63], v[204:207], v[148:151], v[48:63]
  s_waitcnt lgkmcnt(0)
  s_barrier
  s_waitcnt vmcnt(9)
  v_mfma_f32_32x32x16_bf16 v[32:47], v[208:211], v[152:155], v[32:47]
  ds_read_b64_tr_b16 v[192:193], v12 offset:8192
  ds_read_b64_tr_b16 v[194:195], v12 offset:9216
  ds_read_b64_tr_b16 v[196:197], v13 offset:8192
  v_mfma_f32_32x32x16_bf16 v[48:63], v[212:215], v[152:155], v[48:63]
  ds_read_b64_tr_b16 v[198:199], v13 offset:9216
  ds_read_b64_tr_b16 v[200:201], v12 offset:10240
  ds_read_b64_tr_b16 v[202:203], v12 offset:11264
	s_nop 0
  s_waitcnt vmcnt(8)
  v_mfma_f32_32x32x16_bf16 v[32:47], v[216:219], v[156:159], v[32:47]
  ds_read_b64_tr_b16 v[204:205], v13 offset:10240
  ds_read_b64_tr_b16 v[206:207], v13 offset:11264
  v_mfma_f32_32x32x16_bf16 v[48:63], v[220:223], v[156:159], v[48:63]
	s_nop 0
  s_waitcnt vmcnt(7) lgkmcnt(6)
  v_mfma_f32_32x32x16_bf16 v[32:47], v[192:195], v[160:163], v[32:47]
  ds_read_b64_tr_b16 v[208:209], v12 offset:12288
  ds_read_b64_tr_b16 v[210:211], v12 offset:13312
  ds_read_b64_tr_b16 v[212:213], v13 offset:12288
	s_nop 0
  s_waitcnt lgkmcnt(7)
  v_mfma_f32_32x32x16_bf16 v[48:63], v[196:199], v[160:163], v[48:63]
  ds_read_b64_tr_b16 v[214:215], v13 offset:13312
  ds_read_b64_tr_b16 v[216:217], v12 offset:14336
  ds_read_b64_tr_b16 v[218:219], v12 offset:15360
	s_nop 0
  s_waitcnt vmcnt(6) lgkmcnt(8)
  v_mfma_f32_32x32x16_bf16 v[32:47], v[200:203], v[164:167], v[32:47]
  ds_read_b64_tr_b16 v[220:221], v13 offset:14336
  ds_read_b64_tr_b16 v[222:223], v13 offset:15360
  s_waitcnt lgkmcnt(8)
  v_mfma_f32_32x32x16_bf16 v[48:63], v[204:207], v[164:167], v[48:63]
  s_waitcnt vmcnt(5) lgkmcnt(6)
  v_mfma_f32_32x32x16_bf16 v[32:47], v[208:211], v[168:171], v[32:47]
  ds_read_b64_tr_b16 v[192:193], v12 offset:16384
  ds_read_b64_tr_b16 v[194:195], v12 offset:17408
  ds_read_b64_tr_b16 v[196:197], v13 offset:16384
	s_nop 0
  s_waitcnt lgkmcnt(7)
  v_mfma_f32_32x32x16_bf16 v[48:63], v[212:215], v[168:171], v[48:63]
  ds_read_b64_tr_b16 v[198:199], v13 offset:17408
  ds_read_b64_tr_b16 v[200:201], v12 offset:18432
  ds_read_b64_tr_b16 v[202:203], v12 offset:19456
	s_nop 0
  s_waitcnt vmcnt(4) lgkmcnt(8)
  v_mfma_f32_32x32x16_bf16 v[32:47], v[216:219], v[172:175], v[32:47]
  ds_read_b64_tr_b16 v[204:205], v13 offset:18432
  ds_read_b64_tr_b16 v[206:207], v13 offset:19456
  s_waitcnt lgkmcnt(8)
  v_mfma_f32_32x32x16_bf16 v[48:63], v[220:223], v[172:175], v[48:63]
  s_waitcnt vmcnt(3) lgkmcnt(6)
  v_mfma_f32_32x32x16_bf16 v[32:47], v[192:195], v[176:179], v[32:47]
  ds_read_b64_tr_b16 v[208:209], v12 offset:20480
  ds_read_b64_tr_b16 v[210:211], v12 offset:21504
  ds_read_b64_tr_b16 v[212:213], v13 offset:20480
	s_nop 0
  s_waitcnt lgkmcnt(7)
  v_mfma_f32_32x32x16_bf16 v[48:63], v[196:199], v[176:179], v[48:63]
  ds_read_b64_tr_b16 v[214:215], v13 offset:21504
  ds_read_b64_tr_b16 v[216:217], v12 offset:22528
  ds_read_b64_tr_b16 v[218:219], v12 offset:23552
	s_nop 0
  s_waitcnt vmcnt(2) lgkmcnt(8)
  v_mfma_f32_32x32x16_bf16 v[32:47], v[200:203], v[180:183], v[32:47]
  ds_read_b64_tr_b16 v[220:221], v13 offset:22528
  ds_read_b64_tr_b16 v[222:223], v13 offset:23552
  s_waitcnt lgkmcnt(8)
  v_mfma_f32_32x32x16_bf16 v[48:63], v[204:207], v[180:183], v[48:63]
  s_waitcnt vmcnt(1) lgkmcnt(6)
  v_mfma_f32_32x32x16_bf16 v[32:47], v[208:211], v[184:187], v[32:47]
  s_waitcnt lgkmcnt(4)
  v_mfma_f32_32x32x16_bf16 v[48:63], v[212:215], v[184:187], v[48:63]
  s_waitcnt vmcnt(0) lgkmcnt(2)
  v_mfma_f32_32x32x16_bf16 v[32:47], v[216:219], v[188:191], v[32:47]
  s_waitcnt lgkmcnt(0)
  v_mfma_f32_32x32x16_bf16 v[48:63], v[220:223], v[188:191], v[48:63]
  v_and_b32 v20, 31, v1
  s_lshl_b32 s46, s44, 7
  s_lshl_b32 s47, s40, 5
  s_add_u32 s46, s46, s47
  v_add_u32 v20, s46, v20
  v_lshlrev_b32 v20, 12, v20
  v_lshrrev_b32 v21, 5, v1
  v_lshlrev_b32 v21, 4, v21
  v_add3_u32 v20, v20, v21, s55
  s_nop 0
  v_cvt_pk_bf16_f32 v64, v32, v33
  v_cvt_pk_bf16_f32 v65, v34, v35
  v_cvt_pk_bf16_f32 v66, v36, v37
  v_cvt_pk_bf16_f32 v67, v38, v39
  s_nop 0
  v_permlane32_swap_b32 v64, v66
  v_permlane32_swap_b32_e64 v65, v67
  buffer_store_dwordx4 v[64:67], v20, s[36:39], 0 offen offset:0
  v_cvt_pk_bf16_f32 v68, v40, v41
  v_cvt_pk_bf16_f32 v69, v42, v43
  v_cvt_pk_bf16_f32 v70, v44, v45
  v_cvt_pk_bf16_f32 v71, v46, v47
  s_nop 0
  v_permlane32_swap_b32 v68, v70
  v_permlane32_swap_b32_e64 v69, v71
  buffer_store_dwordx4 v[68:71], v20, s[36:39], 0 offen offset:32
  v_cvt_pk_bf16_f32 v72, v48, v49
  v_cvt_pk_bf16_f32 v73, v50, v51
  v_cvt_pk_bf16_f32 v74, v52, v53
  v_cvt_pk_bf16_f32 v75, v54, v55
  s_nop 0
  v_permlane32_swap_b32 v72, v74
  v_permlane32_swap_b32_e64 v73, v75
  buffer_store_dwordx4 v[72:75], v20, s[36:39], 0 offen offset:64
  v_cvt_pk_bf16_f32 v76, v56, v57
  v_cvt_pk_bf16_f32 v77, v58, v59
  v_cvt_pk_bf16_f32 v78, v60, v61
  v_cvt_pk_bf16_f32 v79, v62, v63
  s_nop 0
  v_permlane32_swap_b32 v76, v78
  v_permlane32_swap_b32_e64 v77, v79
  buffer_store_dwordx4 v[76:79], v20, s[36:39], 0 offen offset:96
  s_endpgm
.section .rodata,"a"
.p2align 6
.amdhsa_kernel concat_heads__linear_attn_block__spectral_gfnet__prompt_kernel
  .amdhsa_next_free_vgpr 256
  .amdhsa_next_free_sgpr 102
  .amdhsa_accum_offset 256
  .amdhsa_group_segment_fixed_size 0
  .amdhsa_kernarg_size 72
  .amdhsa_user_sgpr_count 2
  .amdhsa_user_sgpr_kernarg_segment_ptr 1
  .amdhsa_system_sgpr_workgroup_id_x 1
.end_amdhsa_kernel
```
